```python
import torch

def _softmax(x, axis=-1):
    return torch.softmax(x, dim=axis)
def _gelu(x):
    return torch.nn.functional.gelu(x, approximate="tanh")
def _silu(x):
    return torch.nn.functional.silu(x)
def _sigmoid(x):
    return torch.sigmoid(x)
def _layernorm(x, axis=-1, eps=1e-5):
    m = x.mean(dim=axis, keepdim=True)
    v = x.var(dim=axis, keepdim=True, unbiased=False)
    return (x - m) / torch.sqrt(v + eps)
def _scatter_add(tgt, idx, src, axis=0):
    return tgt.clone().index_add_(axis, idx, src)
def _segment_sum(src, seg, n):
    out = torch.zeros((n,) + src.shape[1:], dtype=src.dtype)
    return out.index_add_(0, seg, src)
def _pad(x, pw):
    flat = tuple(v for pair in reversed(pw) for v in pair)
    return torch.nn.functional.pad(x, flat)

kernel_name = 'concat_heads__sliding_block__mha_block__prompt'

def setup_inputs():

    _w = (lambda a: (lambda t: t.to(torch.bfloat16) if t.is_floating_point() else t)(torch.as_tensor(a)))
    def _A_setup():
        B, S, D = 1, 2048, 1024
        return {
            "x": _w((lambda *s: torch.randn(*s, dtype=torch.bfloat16) * 0.2)(B, S, D)),
            "wqkv": _w((lambda *s: torch.randn(*s, dtype=torch.bfloat16) * 0.8)(D, 3 * D)),
            "wo": _w((lambda *s: torch.randn(*s, dtype=torch.bfloat16) * 0.8)(D, D)),
        }
    _A_in = _A_setup()

    def _B_setup():
        B, S, D, H = 1, 2048, 1024, 32
        return {
            "x": _w((lambda *s: torch.randn(*s, dtype=torch.bfloat16) * 0.2)(B, S, D)),
            "wqkv": _w((lambda *s: torch.randn(*s, dtype=torch.bfloat16) * 0.8)(D, 3 * D)),
            "wo": _w((lambda *s: torch.randn(*s, dtype=torch.bfloat16) * 0.8)(D, D)),
        }
    _B_in = _B_setup()

    return {
        "A_x": _A_in["x"],
        "A_wqkv": _A_in["wqkv"],
        "A_wo": _A_in["wo"],
        "B_x": _B_in["x"],
        "B_wqkv": _B_in["wqkv"],
        "B_wo": _B_in["wo"],
    }

def reference(A_x, A_wqkv, A_wo, B_x, B_wqkv, B_wo):
    def _A_ref(x, wqkv, wo):
        B, S, D = x.shape
        H = 32; Dh = D // H; W = 256
        qkv = (lambda x, *d: x.permute(*d))((x @ wqkv).reshape(B, S, 3, H, Dh), 2, 0, 3, 1, 4)
        q, k, v = qkv[0], qkv[1], qkv[2]
        scores = torch.einsum("bhqd,bhkd->bhqk", q, k) * (Dh ** -0.5)
        idx = torch.arange(S)
        mask = (idx[:, None] - idx[None, :] >= 0) & (idx[:, None] - idx[None, :] < W)
        scores = torch.where(mask[None, None], scores, -1e9)
        p = _softmax(scores, axis=-1)
        o = torch.einsum("bhqk,bhkd->bhqd", p, v)
        return (lambda x, *d: x.permute(*d))(o, 0, 2, 1, 3).reshape(B, S, D) @ wo

    def _B_ref(x, wqkv, wo):
        B, S, D = x.shape
        H = 32
        Dh = D // H
        qkv = (lambda x, *d: x.permute(*d))((x @ wqkv).reshape(B, S, 3, H, Dh), 2, 0, 3, 1, 4)
        q, k, v = qkv[0], qkv[1], qkv[2]
        scores = torch.einsum("bhqd,bhkd->bhqk", q, k) * (Dh ** -0.5)
        p = _softmax(scores, axis=-1)
        o = torch.einsum("bhqk,bhkd->bhqd", p, v)
        return (lambda x, *d: x.permute(*d))(o, 0, 2, 1, 3).reshape(B, S, D) @ wo

    a = _A_ref(A_x, A_wqkv, A_wo)
    b = _B_ref(B_x, B_wqkv, B_wo)
    return torch.concatenate([a, b], axis=-1)
```

```asm
; @launch kernel=fused_kernel grid=(256,1,1) block=(512,1,1) lds=163840
.amdgcn_target "amdgcn-amd-amdhsa--gfx950"
.text
.globl fused_kernel
.p2align 8
.type fused_kernel,@function
fused_kernel:
    s_cmp_ge_u32 s2, 256
    s_cbranch_scc1 L_f_end
    s_load_dwordx4 s[20:23], s[0:1], 0
    s_load_dwordx2 s[24:25], s[0:1], 24
    s_load_dwordx2 s[26:27], s[0:1], 32
    s_load_dwordx2 s[28:29], s[0:1], 64
    s_load_dwordx2 s[18:19], s[0:1], 56
    v_lshrrev_b32 v1, 6, v0
    v_and_b32 v0, 63, v0
    s_and_b32 s30, s2, 7
    s_lshr_b32 s31, s2, 3
    v_readfirstlane_b32 s16, v1
    s_and_b32 s33, s30, 1
    s_lshl_b32 s33, s33, 3
    s_and_b32 s34, s31, 7
    s_add_u32 s33, s33, s34
    s_lshr_b32 s34, s30, 1
    s_lshl_b32 s34, s34, 2
    s_lshr_b32 s35, s31, 3
    s_add_u32 s34, s34, s35
    s_and_b32 s59, s16, 3
    v_mov_b32 v255, 1
    s_cmp_lt_u32 s16, 4
    s_cbranch_scc1 L_x
    v_lshrrev_b32 v1, 3, v0
    v_and_b32 v2, 7, v0
    v_lshrrev_b32 v3, 4, v0
    s_lshl_b32 s37, s33, 7
    s_lshl_b32 s38, s59, 5
    s_add_u32 s37, s37, s38
    v_add_u32 v4, s37, v1
    v_lshlrev_b32 v4, 11, v4
    v_xor_b32 v5, v2, v3
    v_xor_b32 v6, 4, v5
    v_lshl_add_u32 v232, v5, 4, v4
    v_lshl_add_u32 v6, v6, 4, v4
    v_add_u32 v233, 15360, v6
    v_add_u32 v234, 30720, v232
    v_add_u32 v235, 46080, v6
    s_lshl_b32 s38, s59, 4
    v_add_u32 v4, s38, v1
    s_mov_b32 s39, 6144
    v_mul_lo_u32 v4, v4, s39
    v_and_b32 v3, 1, v3
    v_lshlrev_b32 v3, 1, v3
    v_xor_b32 v5, v2, v3
    v_xor_b32 v6, 4, v5
    s_lshl_b32 s38, s34, 7
    v_add_u32 v4, s38, v4
    v_lshl_add_u32 v5, v5, 4, v4
    v_lshl_add_u32 v6, v6, 4, v4
    v_add_u32 v236, 0, v5
    v_add_u32 v237, 48128, v6
    v_add_u32 v238, 0, v5
    v_add_u32 v239, 51200, v6
    v_add_u32 v240, 3072, v5
    v_add_u32 v241, 51200, v6
    s_lshl_b32 s40, s59, 12
    s_mul_i32 s41, s59, 6144
    s_add_u32 s41, s41, 16384
    s_add_u32 s58, s34, s33
    s_and_b32 s58, s58, 3
    s_mov_b32 s60, 0x65473210
    s_mov_b32 s61, 0xedcfa98b
    s_mov_b32 s62, 0x65473210
    s_mov_b32 s63, 0xedcfa98b
    s_cmp_eq_u32 s58, 1
    s_cselect_b32 s60, 0x65803241, s60
    s_cselect_b32 s61, 0xfedba9c7, s61
    s_cselect_b32 s62, 0x65803241, s62
    s_cselect_b32 s63, 0xfedba9c7, s63
    s_cmp_eq_u32 s58, 2
    s_cselect_b32 s60, 0x69410532, s60
    s_cselect_b32 s61, 0xfecbad87, s61
    s_cselect_b32 s62, 0x69410532, s62
    s_cselect_b32 s63, 0xfecbad87, s63
    s_cmp_eq_u32 s58, 3
    s_cselect_b32 s60, 0xa5426103, s60
    s_cselect_b32 s61, 0xfdcbe987, s61
    s_cselect_b32 s62, 0xa5426103, s62
    s_cselect_b32 s63, 0xfdcbe987, s63
    s_waitcnt lgkmcnt(0)
    s_mov_b32 s4, s24
    s_mov_b32 s5, s25
    s_mov_b32 s6, 0x400000
    s_mov_b32 s7, 0x00020000
    s_mov_b32 s8, s26
    s_mov_b32 s9, s27
    s_mov_b32 s10, 0x600000
    s_mov_b32 s11, 0x00020000
    s_mov_b32 s12, s28
    s_mov_b32 s13, s29
    s_mov_b32 s14, 0x2200000
    s_mov_b32 s15, 0x00020000
    s_bfe_u32 s44, s60, 0x40000
    s_add_u32 m0, s40, 0
    s_lshl_b32 s42, s44, 7
    s_mul_i32 s43, s44, 393216
    buffer_load_dwordx4 v232, s[4:7], s42 offen offset:0 lds
    buffer_load_dwordx4 v233, s[4:7], s42 offen offset:1024 lds
    buffer_load_dwordx4 v234, s[4:7], s42 offen offset:2048 lds
    buffer_load_dwordx4 v235, s[4:7], s42 offen offset:3072 lds
    s_add_u32 m0, s41, 0
    s_nop 0
    buffer_load_dwordx4 v236, s[8:11], s43 offen offset:0 lds
    buffer_load_dwordx4 v237, s[8:11], s43 offen offset:1024 lds
    buffer_load_dwordx4 v238, s[8:11], s43 offen offset:2048 lds
    s_add_u32 m0, s41, 3072
    s_nop 0
    buffer_load_dwordx4 v239, s[8:11], s43 offen offset:0 lds
    buffer_load_dwordx4 v240, s[8:11], s43 offen offset:1024 lds
    buffer_load_dwordx4 v241, s[8:11], s43 offen offset:2048 lds
    s_lshr_b32 s36, s59, 1
    s_and_b32 s37, s59, 1
    v_and_b32 v6, 15, v0
    v_lshrrev_b32 v8, 4, v0
    v_bfe_u32 v5, v0, 1, 3
    v_lshlrev_b32 v6, 7, v6
    s_lshl_b32 s38, s36, 13
    s_add_u32 s38, s38, 40960
    v_add_u32 v6, s38, v6
    v_xor_b32 v1, v8, v5
    v_xor_b32 v2, 4, v1
    v_lshl_add_u32 v1, v1, 4, v6
    v_lshl_add_u32 v2, v2, 4, v6
    v_lshrrev_b32 v6, 5, v0
    s_mov_b32 s39, 6144
    v_mul_lo_u32 v6, v6, s39
    v_and_b32 v8, 1, v8
    v_bfe_u32 v5, v0, 2, 2
    v_lshl_add_u32 v5, v8, 3, v5
    v_lshl_add_u32 v6, v5, 7, v6
    v_and_b32 v5, 3, v0
    v_lshl_add_u32 v6, v5, 3, v6
    v_add_u32 v6, 57344, v6
    v_bfe_u32 v5, v0, 3, 1
    v_lshl_or_b32 v5, v8, 1, v5
    s_lshl_b32 s38, s37, 1
    v_xor_b32 v5, s38, v5
    v_lshl_add_u32 v3, v5, 5, v6
    v_xor_b32 v5, 1, v5
    v_lshl_add_u32 v4, v5, 5, v6
    s_lshl_b32 s44, s34, 1
    s_add_u32 s44, s44, s37
    s_lshl_b32 s44, s44, 6
    s_lshl_b32 s45, s33, 2
    s_add_u32 s44, s44, s45
    s_lshl_b32 s45, s36, 1
    s_add_u32 s44, s44, s45
    s_lshl_b32 s65, s44, 12
    s_add_u32 s65, s65, 8388608
    s_mov_b32 s67, 0x3e8293ee
    v_and_b32 v5, 15, v0
    v_lshrrev_b32 v6, 4, v0
    v_lshlrev_b32 v5, 4, v5
    v_lshl_add_u32 v5, v6, 9, v5
    s_mov_b32 s17, 0
    s_mov_b32 s48, 0
    v_mov_b32 v64, 0
    v_mov_b32 v65, 0
    v_mov_b32 v66, 0
    v_mov_b32 v67, 0
    v_mov_b32 v68, 0
    v_mov_b32 v69, 0
    v_mov_b32 v70, 0
    v_mov_b32 v71, 0
    v_mov_b32 v72, 0
    v_mov_b32 v73, 0
    v_mov_b32 v74, 0
    v_mov_b32 v75, 0
    v_mov_b32 v76, 0
    v_mov_b32 v77, 0
    v_mov_b32 v78, 0
    v_mov_b32 v79, 0
    v_mov_b32 v80, 0
    v_mov_b32 v81, 0
    v_mov_b32 v82, 0
    v_mov_b32 v83, 0
    v_mov_b32 v84, 0
    v_mov_b32 v85, 0
    v_mov_b32 v86, 0
    v_mov_b32 v87, 0
    v_mov_b32 v88, 0
    v_mov_b32 v89, 0
    v_mov_b32 v90, 0
    v_mov_b32 v91, 0
    v_mov_b32 v92, 0
    v_mov_b32 v93, 0
    v_mov_b32 v94, 0
    v_mov_b32 v95, 0
    v_mov_b32 v96, 0
    v_mov_b32 v97, 0
    v_mov_b32 v98, 0
    v_mov_b32 v99, 0
    v_mov_b32 v100, 0
    v_mov_b32 v101, 0
    v_mov_b32 v102, 0
    v_mov_b32 v103, 0
    v_mov_b32 v104, 0
    v_mov_b32 v105, 0
    v_mov_b32 v106, 0
    v_mov_b32 v107, 0
    v_mov_b32 v108, 0
    v_mov_b32 v109, 0
    v_mov_b32 v110, 0
    v_mov_b32 v111, 0
    v_mov_b32 v112, 0
    v_mov_b32 v113, 0
    v_mov_b32 v114, 0
    v_mov_b32 v115, 0
    v_mov_b32 v116, 0
    v_mov_b32 v117, 0
    v_mov_b32 v118, 0
    v_mov_b32 v119, 0
    v_mov_b32 v120, 0
    v_mov_b32 v121, 0
    v_mov_b32 v122, 0
    v_mov_b32 v123, 0
    v_mov_b32 v124, 0
    v_mov_b32 v125, 0
    v_mov_b32 v126, 0
    v_mov_b32 v127, 0
    v_mov_b32 v128, 0
    v_mov_b32 v129, 0
    v_mov_b32 v130, 0
    v_mov_b32 v131, 0
    v_mov_b32 v132, 0
    v_mov_b32 v133, 0
    v_mov_b32 v134, 0
    v_mov_b32 v135, 0
    v_mov_b32 v136, 0
    v_mov_b32 v137, 0
    v_mov_b32 v138, 0
    v_mov_b32 v139, 0
    v_mov_b32 v140, 0
    v_mov_b32 v141, 0
    v_mov_b32 v142, 0
    v_mov_b32 v143, 0
    v_mov_b32 v144, 0
    v_mov_b32 v145, 0
    v_mov_b32 v146, 0
    v_mov_b32 v147, 0
    v_mov_b32 v148, 0
    v_mov_b32 v149, 0
    v_mov_b32 v150, 0
    v_mov_b32 v151, 0
    v_mov_b32 v152, 0
    v_mov_b32 v153, 0
    v_mov_b32 v154, 0
    v_mov_b32 v155, 0
    v_mov_b32 v156, 0
    v_mov_b32 v157, 0
    v_mov_b32 v158, 0
    v_mov_b32 v159, 0
    v_lshlrev_b32 v254, 2, v0
    v_add_u32 v254, 163328, v254
    s_bfe_u32 s44, s60, 0x40004
    s_add_u32 m0, s40, 40960
    s_lshl_b32 s42, s44, 7
    s_mul_i32 s43, s44, 393216
    buffer_load_dwordx4 v232, s[4:7], s42 offen offset:0 lds
    buffer_load_dwordx4 v233, s[4:7], s42 offen offset:1024 lds
    buffer_load_dwordx4 v234, s[4:7], s42 offen offset:2048 lds
    buffer_load_dwordx4 v235, s[4:7], s42 offen offset:3072 lds
    s_add_u32 m0, s41, 40960
    s_nop 0
    buffer_load_dwordx4 v236, s[8:11], s43 offen offset:0 lds
    buffer_load_dwordx4 v237, s[8:11], s43 offen offset:1024 lds
    buffer_load_dwordx4 v238, s[8:11], s43 offen offset:2048 lds
    s_add_u32 m0, s41, 44032
    s_nop 0
    buffer_load_dwordx4 v239, s[8:11], s43 offen offset:0 lds
    buffer_load_dwordx4 v240, s[8:11], s43 offen offset:1024 lds
    buffer_load_dwordx4 v241, s[8:11], s43 offen offset:2048 lds
    s_waitcnt vmcnt(10)
    s_barrier
    s_bfe_u32 s44, s60, 0x40008
    s_add_u32 m0, s40, 81920
    s_lshl_b32 s42, s44, 7
    s_mul_i32 s43, s44, 393216
    buffer_load_dwordx4 v232, s[4:7], s42 offen offset:0 lds
    buffer_load_dwordx4 v233, s[4:7], s42 offen offset:1024 lds
    buffer_load_dwordx4 v234, s[4:7], s42 offen offset:2048 lds
    buffer_load_dwordx4 v235, s[4:7], s42 offen offset:3072 lds
    s_add_u32 m0, s41, 81920
    s_nop 0
    buffer_load_dwordx4 v236, s[8:11], s43 offen offset:0 lds
    buffer_load_dwordx4 v237, s[8:11], s43 offen offset:1024 lds
    buffer_load_dwordx4 v238, s[8:11], s43 offen offset:2048 lds
    s_add_u32 m0, s41, 84992
    s_nop 0
    buffer_load_dwordx4 v239, s[8:11], s43 offen offset:0 lds
    buffer_load_dwordx4 v240, s[8:11], s43 offen offset:1024 lds
    buffer_load_dwordx4 v241, s[8:11], s43 offen offset:2048 lds
    s_waitcnt vmcnt(10)
    s_barrier
    s_bfe_u32 s44, s60, 0x4000c
    s_add_u32 m0, s40, 0
    s_lshl_b32 s42, s44, 7
    s_mul_i32 s43, s44, 393216
    buffer_load_dwordx4 v232, s[4:7], s42 offen offset:0 lds
    buffer_load_dwordx4 v233, s[4:7], s42 offen offset:1024 lds
    buffer_load_dwordx4 v234, s[4:7], s42 offen offset:2048 lds
    buffer_load_dwordx4 v235, s[4:7], s42 offen offset:3072 lds
    s_add_u32 m0, s41, 0
    s_nop 0
    buffer_load_dwordx4 v236, s[8:11], s43 offen offset:0 lds
    buffer_load_dwordx4 v237, s[8:11], s43 offen offset:1024 lds
    buffer_load_dwordx4 v238, s[8:11], s43 offen offset:2048 lds
    s_add_u32 m0, s41, 3072
    s_nop 0
    buffer_load_dwordx4 v239, s[8:11], s43 offen offset:0 lds
    buffer_load_dwordx4 v240, s[8:11], s43 offen offset:1024 lds
    buffer_load_dwordx4 v241, s[8:11], s43 offen offset:2048 lds
    s_waitcnt vmcnt(10)
    s_barrier
    s_bfe_u32 s44, s60, 0x40010
    s_add_u32 m0, s40, 40960
    s_lshl_b32 s42, s44, 7
    s_mul_i32 s43, s44, 393216
    buffer_load_dwordx4 v232, s[4:7], s42 offen offset:0 lds
    buffer_load_dwordx4 v233, s[4:7], s42 offen offset:1024 lds
    buffer_load_dwordx4 v234, s[4:7], s42 offen offset:2048 lds
    buffer_load_dwordx4 v235, s[4:7], s42 offen offset:3072 lds
    s_add_u32 m0, s41, 40960
    s_nop 0
    buffer_load_dwordx4 v236, s[8:11], s43 offen offset:0 lds
    buffer_load_dwordx4 v237, s[8:11], s43 offen offset:1024 lds
    buffer_load_dwordx4 v238, s[8:11], s43 offen offset:2048 lds
    s_add_u32 m0, s41, 44032
    s_nop 0
    buffer_load_dwordx4 v239, s[8:11], s43 offen offset:0 lds
    buffer_load_dwordx4 v240, s[8:11], s43 offen offset:1024 lds
    buffer_load_dwordx4 v241, s[8:11], s43 offen offset:2048 lds
    s_waitcnt vmcnt(10)
    s_barrier
    s_bfe_u32 s44, s60, 0x40014
    s_add_u32 m0, s40, 81920
    s_lshl_b32 s42, s44, 7
    s_mul_i32 s43, s44, 393216
    buffer_load_dwordx4 v232, s[4:7], s42 offen offset:0 lds
    buffer_load_dwordx4 v233, s[4:7], s42 offen offset:1024 lds
    buffer_load_dwordx4 v234, s[4:7], s42 offen offset:2048 lds
    buffer_load_dwordx4 v235, s[4:7], s42 offen offset:3072 lds
    s_add_u32 m0, s41, 81920
    s_nop 0
    buffer_load_dwordx4 v236, s[8:11], s43 offen offset:0 lds
    buffer_load_dwordx4 v237, s[8:11], s43 offen offset:1024 lds
    buffer_load_dwordx4 v238, s[8:11], s43 offen offset:2048 lds
    s_add_u32 m0, s41, 84992
    s_nop 0
    buffer_load_dwordx4 v239, s[8:11], s43 offen offset:0 lds
    buffer_load_dwordx4 v240, s[8:11], s43 offen offset:1024 lds
    buffer_load_dwordx4 v241, s[8:11], s43 offen offset:2048 lds
    s_waitcnt vmcnt(10)
    s_barrier
    s_bfe_u32 s44, s60, 0x40018
    s_add_u32 m0, s40, 0
    s_lshl_b32 s42, s44, 7
    s_mul_i32 s43, s44, 393216
    buffer_load_dwordx4 v232, s[4:7], s42 offen offset:0 lds
    buffer_load_dwordx4 v233, s[4:7], s42 offen offset:1024 lds
    buffer_load_dwordx4 v234, s[4:7], s42 offen offset:2048 lds
    buffer_load_dwordx4 v235, s[4:7], s42 offen offset:3072 lds
    s_add_u32 m0, s41, 0
    s_nop 0
    buffer_load_dwordx4 v236, s[8:11], s43 offen offset:0 lds
    buffer_load_dwordx4 v237, s[8:11], s43 offen offset:1024 lds
    buffer_load_dwordx4 v238, s[8:11], s43 offen offset:2048 lds
    s_add_u32 m0, s41, 3072
    s_nop 0
    buffer_load_dwordx4 v239, s[8:11], s43 offen offset:0 lds
    buffer_load_dwordx4 v240, s[8:11], s43 offen offset:1024 lds
    buffer_load_dwordx4 v241, s[8:11], s43 offen offset:2048 lds
    s_waitcnt vmcnt(10)
    s_barrier
    s_bfe_u32 s44, s60, 0x4001c
    s_add_u32 m0, s40, 40960
    s_lshl_b32 s42, s44, 7
    s_mul_i32 s43, s44, 393216
    buffer_load_dwordx4 v232, s[4:7], s42 offen offset:0 lds
    buffer_load_dwordx4 v233, s[4:7], s42 offen offset:1024 lds
    buffer_load_dwordx4 v234, s[4:7], s42 offen offset:2048 lds
    buffer_load_dwordx4 v235, s[4:7], s42 offen offset:3072 lds
    s_add_u32 m0, s41, 40960
    s_nop 0
    buffer_load_dwordx4 v236, s[8:11], s43 offen offset:0 lds
    buffer_load_dwordx4 v237, s[8:11], s43 offen offset:1024 lds
    buffer_load_dwordx4 v238, s[8:11], s43 offen offset:2048 lds
    s_add_u32 m0, s41, 44032
    s_nop 0
    buffer_load_dwordx4 v239, s[8:11], s43 offen offset:0 lds
    buffer_load_dwordx4 v240, s[8:11], s43 offen offset:1024 lds
    buffer_load_dwordx4 v241, s[8:11], s43 offen offset:2048 lds
    s_waitcnt vmcnt(10)
    s_barrier
    s_bfe_u32 s44, s61, 0x40000
    s_add_u32 m0, s40, 81920
    s_lshl_b32 s42, s44, 7
    s_mul_i32 s43, s44, 393216
    buffer_load_dwordx4 v232, s[4:7], s42 offen offset:0 lds
    buffer_load_dwordx4 v233, s[4:7], s42 offen offset:1024 lds
    buffer_load_dwordx4 v234, s[4:7], s42 offen offset:2048 lds
    buffer_load_dwordx4 v235, s[4:7], s42 offen offset:3072 lds
    s_add_u32 m0, s41, 81920
    s_nop 0
    buffer_load_dwordx4 v236, s[8:11], s43 offen offset:0 lds
    buffer_load_dwordx4 v237, s[8:11], s43 offen offset:1024 lds
    buffer_load_dwordx4 v238, s[8:11], s43 offen offset:2048 lds
    s_add_u32 m0, s41, 84992
    s_nop 0
    buffer_load_dwordx4 v239, s[8:11], s43 offen offset:0 lds
    buffer_load_dwordx4 v240, s[8:11], s43 offen offset:1024 lds
    buffer_load_dwordx4 v241, s[8:11], s43 offen offset:2048 lds
    s_waitcnt vmcnt(10)
    s_barrier
    s_bfe_u32 s44, s61, 0x40004
    s_add_u32 m0, s40, 0
    s_lshl_b32 s42, s44, 7
    s_mul_i32 s43, s44, 393216
    buffer_load_dwordx4 v232, s[4:7], s42 offen offset:0 lds
    buffer_load_dwordx4 v233, s[4:7], s42 offen offset:1024 lds
    buffer_load_dwordx4 v234, s[4:7], s42 offen offset:2048 lds
    buffer_load_dwordx4 v235, s[4:7], s42 offen offset:3072 lds
    s_add_u32 m0, s41, 0
    s_nop 0
    buffer_load_dwordx4 v236, s[8:11], s43 offen offset:0 lds
    buffer_load_dwordx4 v237, s[8:11], s43 offen offset:1024 lds
    buffer_load_dwordx4 v238, s[8:11], s43 offen offset:2048 lds
    s_add_u32 m0, s41, 3072
    s_nop 0
    buffer_load_dwordx4 v239, s[8:11], s43 offen offset:0 lds
    buffer_load_dwordx4 v240, s[8:11], s43 offen offset:1024 lds
    buffer_load_dwordx4 v241, s[8:11], s43 offen offset:2048 lds
    s_waitcnt vmcnt(10)
    s_barrier
    s_bfe_u32 s44, s61, 0x40008
    s_add_u32 m0, s40, 40960
    s_lshl_b32 s42, s44, 7
    s_mul_i32 s43, s44, 393216
    buffer_load_dwordx4 v232, s[4:7], s42 offen offset:0 lds
    buffer_load_dwordx4 v233, s[4:7], s42 offen offset:1024 lds
    buffer_load_dwordx4 v234, s[4:7], s42 offen offset:2048 lds
    buffer_load_dwordx4 v235, s[4:7], s42 offen offset:3072 lds
    s_add_u32 m0, s41, 40960
    s_nop 0
    buffer_load_dwordx4 v236, s[8:11], s43 offen offset:0 lds
    buffer_load_dwordx4 v237, s[8:11], s43 offen offset:1024 lds
    buffer_load_dwordx4 v238, s[8:11], s43 offen offset:2048 lds
    s_add_u32 m0, s41, 44032
    s_nop 0
    buffer_load_dwordx4 v239, s[8:11], s43 offen offset:0 lds
    buffer_load_dwordx4 v240, s[8:11], s43 offen offset:1024 lds
    buffer_load_dwordx4 v241, s[8:11], s43 offen offset:2048 lds
    s_waitcnt vmcnt(10)
    s_barrier
    s_bfe_u32 s44, s61, 0x4000c
    s_add_u32 m0, s40, 81920
    s_lshl_b32 s42, s44, 7
    s_mul_i32 s43, s44, 393216
    buffer_load_dwordx4 v232, s[4:7], s42 offen offset:0 lds
    buffer_load_dwordx4 v233, s[4:7], s42 offen offset:1024 lds
    buffer_load_dwordx4 v234, s[4:7], s42 offen offset:2048 lds
    buffer_load_dwordx4 v235, s[4:7], s42 offen offset:3072 lds
    s_add_u32 m0, s41, 81920
    s_nop 0
    buffer_load_dwordx4 v236, s[8:11], s43 offen offset:0 lds
    buffer_load_dwordx4 v237, s[8:11], s43 offen offset:1024 lds
    buffer_load_dwordx4 v238, s[8:11], s43 offen offset:2048 lds
    s_add_u32 m0, s41, 84992
    s_nop 0
    buffer_load_dwordx4 v239, s[8:11], s43 offen offset:0 lds
    buffer_load_dwordx4 v240, s[8:11], s43 offen offset:1024 lds
    buffer_load_dwordx4 v241, s[8:11], s43 offen offset:2048 lds
    s_waitcnt vmcnt(10)
    s_barrier
    s_bfe_u32 s44, s61, 0x40010
    s_add_u32 m0, s40, 0
    s_lshl_b32 s42, s44, 7
    s_mul_i32 s43, s44, 393216
    buffer_load_dwordx4 v232, s[4:7], s42 offen offset:0 lds
    buffer_load_dwordx4 v233, s[4:7], s42 offen offset:1024 lds
    buffer_load_dwordx4 v234, s[4:7], s42 offen offset:2048 lds
    buffer_load_dwordx4 v235, s[4:7], s42 offen offset:3072 lds
    s_add_u32 m0, s41, 0
    s_nop 0
    buffer_load_dwordx4 v236, s[8:11], s43 offen offset:0 lds
    buffer_load_dwordx4 v237, s[8:11], s43 offen offset:1024 lds
    buffer_load_dwordx4 v238, s[8:11], s43 offen offset:2048 lds
    s_add_u32 m0, s41, 3072
    s_nop 0
    buffer_load_dwordx4 v239, s[8:11], s43 offen offset:0 lds
    buffer_load_dwordx4 v240, s[8:11], s43 offen offset:1024 lds
    buffer_load_dwordx4 v241, s[8:11], s43 offen offset:2048 lds
    s_waitcnt vmcnt(10)
    s_barrier
    s_bfe_u32 s44, s61, 0x40014
    s_add_u32 m0, s40, 40960
    s_lshl_b32 s42, s44, 7
    s_mul_i32 s43, s44, 393216
    buffer_load_dwordx4 v232, s[4:7], s42 offen offset:0 lds
    buffer_load_dwordx4 v233, s[4:7], s42 offen offset:1024 lds
    buffer_load_dwordx4 v234, s[4:7], s42 offen offset:2048 lds
    buffer_load_dwordx4 v235, s[4:7], s42 offen offset:3072 lds
    s_add_u32 m0, s41, 40960
    s_nop 0
    buffer_load_dwordx4 v236, s[8:11], s43 offen offset:0 lds
    buffer_load_dwordx4 v237, s[8:11], s43 offen offset:1024 lds
    buffer_load_dwordx4 v238, s[8:11], s43 offen offset:2048 lds
    s_add_u32 m0, s41, 44032
    s_nop 0
    buffer_load_dwordx4 v239, s[8:11], s43 offen offset:0 lds
    buffer_load_dwordx4 v240, s[8:11], s43 offen offset:1024 lds
    buffer_load_dwordx4 v241, s[8:11], s43 offen offset:2048 lds
    s_waitcnt vmcnt(10)
    s_barrier
    s_load_dwordx4 s[68:71], s[18:19], 0
    s_bfe_u32 s44, s61, 0x40018
    s_add_u32 m0, s40, 81920
    s_lshl_b32 s42, s44, 7
    s_mul_i32 s43, s44, 393216
    buffer_load_dwordx4 v232, s[4:7], s42 offen offset:0 lds
    buffer_load_dwordx4 v233, s[4:7], s42 offen offset:1024 lds
    buffer_load_dwordx4 v234, s[4:7], s42 offen offset:2048 lds
    buffer_load_dwordx4 v235, s[4:7], s42 offen offset:3072 lds
    s_add_u32 m0, s41, 81920
    s_nop 0
    buffer_load_dwordx4 v236, s[8:11], s43 offen offset:0 lds
    buffer_load_dwordx4 v237, s[8:11], s43 offen offset:1024 lds
    buffer_load_dwordx4 v238, s[8:11], s43 offen offset:2048 lds
    s_add_u32 m0, s41, 84992
    s_nop 0
    buffer_load_dwordx4 v239, s[8:11], s43 offen offset:0 lds
    buffer_load_dwordx4 v240, s[8:11], s43 offen offset:1024 lds
    buffer_load_dwordx4 v241, s[8:11], s43 offen offset:2048 lds
    s_waitcnt vmcnt(10)
    s_barrier
    s_bfe_u32 s44, s61, 0x4001c
    s_add_u32 m0, s40, 0
    s_lshl_b32 s42, s44, 7
    s_mul_i32 s43, s44, 393216
    buffer_load_dwordx4 v232, s[4:7], s42 offen offset:0 lds
    buffer_load_dwordx4 v233, s[4:7], s42 offen offset:1024 lds
    buffer_load_dwordx4 v234, s[4:7], s42 offen offset:2048 lds
    buffer_load_dwordx4 v235, s[4:7], s42 offen offset:3072 lds
    s_add_u32 m0, s41, 0
    s_nop 0
    buffer_load_dwordx4 v236, s[8:11], s43 offen offset:0 lds
    buffer_load_dwordx4 v237, s[8:11], s43 offen offset:1024 lds
    buffer_load_dwordx4 v238, s[8:11], s43 offen offset:2048 lds
    s_add_u32 m0, s41, 3072
    s_nop 0
    buffer_load_dwordx4 v239, s[8:11], s43 offen offset:0 lds
    buffer_load_dwordx4 v240, s[8:11], s43 offen offset:1024 lds
    buffer_load_dwordx4 v241, s[8:11], s43 offen offset:2048 lds
    s_waitcnt vmcnt(10)
    s_barrier
    s_mov_b32 s4, s20
    s_mov_b32 s5, s21
    s_mov_b32 s8, s22
    s_mov_b32 s9, s23
    s_bfe_u32 s44, s62, 0x40000
    s_add_u32 m0, s40, 40960
    s_lshl_b32 s42, s44, 7
    s_mul_i32 s43, s44, 393216
    buffer_load_dwordx4 v232, s[4:7], s42 offen offset:0 lds
    buffer_load_dwordx4 v233, s[4:7], s42 offen offset:1024 lds
    buffer_load_dwordx4 v234, s[4:7], s42 offen offset:2048 lds
    buffer_load_dwordx4 v235, s[4:7], s42 offen offset:3072 lds
    s_add_u32 m0, s41, 40960
    s_nop 0
    buffer_load_dwordx4 v236, s[8:11], s43 offen offset:0 lds
    buffer_load_dwordx4 v237, s[8:11], s43 offen offset:1024 lds
    buffer_load_dwordx4 v238, s[8:11], s43 offen offset:2048 lds
    s_add_u32 m0, s41, 44032
    s_nop 0
    buffer_load_dwordx4 v239, s[8:11], s43 offen offset:0 lds
    buffer_load_dwordx4 v240, s[8:11], s43 offen offset:1024 lds
    buffer_load_dwordx4 v241, s[8:11], s43 offen offset:2048 lds
    s_waitcnt vmcnt(10)
    s_barrier
    s_bfe_u32 s44, s62, 0x40004
    s_add_u32 m0, s40, 81920
    s_lshl_b32 s42, s44, 7
    s_mul_i32 s43, s44, 393216
    buffer_load_dwordx4 v232, s[4:7], s42 offen offset:0 lds
    buffer_load_dwordx4 v233, s[4:7], s42 offen offset:1024 lds
    buffer_load_dwordx4 v234, s[4:7], s42 offen offset:2048 lds
    buffer_load_dwordx4 v235, s[4:7], s42 offen offset:3072 lds
    s_add_u32 m0, s41, 81920
    s_nop 0
    buffer_load_dwordx4 v236, s[8:11], s43 offen offset:0 lds
    buffer_load_dwordx4 v237, s[8:11], s43 offen offset:1024 lds
    buffer_load_dwordx4 v238, s[8:11], s43 offen offset:2048 lds
    s_add_u32 m0, s41, 84992
    s_nop 0
    buffer_load_dwordx4 v239, s[8:11], s43 offen offset:0 lds
    buffer_load_dwordx4 v240, s[8:11], s43 offen offset:1024 lds
    buffer_load_dwordx4 v241, s[8:11], s43 offen offset:2048 lds
    s_waitcnt vmcnt(10)
    s_barrier
    ds_read_b128 v[8:11], v1 offset:0
    ds_read_b128 v[12:15], v1 offset:2048
    ds_read_b128 v[16:19], v1 offset:4096
    ds_read_b128 v[20:23], v1 offset:6144
    ds_read_b64_tr_b16 v[40:41], v3 offset:0
    ds_read_b64_tr_b16 v[42:43], v3 offset:512
    ds_read_b64_tr_b16 v[44:45], v4 offset:0
    ds_read_b64_tr_b16 v[46:47], v4 offset:512
    ds_read_b64_tr_b16 v[48:49], v3 offset:2048
    ds_read_b64_tr_b16 v[50:51], v3 offset:2560
    ds_read_b64_tr_b16 v[52:53], v4 offset:2048
    ds_read_b64_tr_b16 v[54:55], v4 offset:2560
    ds_read_b64_tr_b16 v[56:57], v3 offset:4096
    ds_read_b64_tr_b16 v[58:59], v3 offset:4608
    ds_read_b64_tr_b16 v[60:61], v4 offset:4096
    ds_read_b64_tr_b16 v[62:63], v4 offset:4608
    s_bfe_u32 s44, s62, 0x40008
    s_add_u32 m0, s40, 0
    s_lshl_b32 s42, s44, 7
    s_mul_i32 s43, s44, 393216
    buffer_load_dwordx4 v232, s[4:7], s42 offen offset:0 lds
    buffer_load_dwordx4 v233, s[4:7], s42 offen offset:1024 lds
    buffer_load_dwordx4 v234, s[4:7], s42 offen offset:2048 lds
    s_setprio 2
    s_lshr_b64 s[62:63], s[62:63], 12
    s_mov_b32 s31, 40960
    s_mov_b32 s45, 1
    s_mov_b32 s57, 40960
    s_mov_b32 s50, s41
    s_waitcnt lgkmcnt(0)
.p2align 6
L_y_loop:
    v_mfma_f32_16x16x32_bf16 v[64:67], v[40:43], v[8:11], v[64:67]
    s_waitcnt lgkmcnt(11)
    ds_read_b64_tr_b16 v[62:63], v4 offset:4608
    v_mfma_f32_16x16x32_bf16 v[80:83], v[40:43], v[12:15], v[80:83]
    s_waitcnt lgkmcnt(11)
    ds_read_b128 v[24:27], v2 offset:0
    v_mfma_f32_16x16x32_bf16 v[96:99], v[40:43], v[16:19], v[96:99]
    s_waitcnt lgkmcnt(11)
    s_setprio 0
    buffer_load_dwordx4 v235, s[4:7], s42 offen offset:3072 lds
    s_setprio 2
    v_mfma_f32_16x16x32_bf16 v[112:115], v[40:43], v[20:23], v[112:115]
    s_waitcnt lgkmcnt(9)
    ds_read_b64_tr_b16 v[40:41], v3 offset:12288
    v_mfma_f32_16x16x32_bf16 v[68:71], v[44:47], v[8:11], v[68:71]
    ds_read_b64_tr_b16 v[42:43], v3 offset:12800
    v_mfma_f32_16x16x32_bf16 v[84:87], v[44:47], v[12:15], v[84:87]
    ds_read_b128 v[28:31], v2 offset:2048
    v_mfma_f32_16x16x32_bf16 v[100:103], v[44:47], v[16:19], v[100:103]
    s_mov_b32 m0, s50
    s_setprio 0
    buffer_load_dwordx4 v236, s[8:11], s43 offen offset:0 lds
    s_setprio 2
    v_mfma_f32_16x16x32_bf16 v[116:119], v[44:47], v[20:23], v[116:119]
    s_waitcnt lgkmcnt(10)
    ds_read_b64_tr_b16 v[44:45], v4 offset:12288
    v_mfma_f32_16x16x32_bf16 v[72:75], v[48:51], v[8:11], v[72:75]
    ds_read_b64_tr_b16 v[46:47], v4 offset:12800
    v_mfma_f32_16x16x32_bf16 v[88:91], v[48:51], v[12:15], v[88:91]
    ds_read_b128 v[32:35], v2 offset:4096
    v_mfma_f32_16x16x32_bf16 v[104:107], v[48:51], v[16:19], v[104:107]
    s_setprio 0
    buffer_load_dwordx4 v237, s[8:11], s43 offen offset:1024 lds
    s_setprio 2
    v_mfma_f32_16x16x32_bf16 v[120:123], v[48:51], v[20:23], v[120:123]
    s_waitcnt lgkmcnt(11)
    ds_read_b64_tr_b16 v[48:49], v3 offset:14336
    v_mfma_f32_16x16x32_bf16 v[76:79], v[52:55], v[8:11], v[76:79]
    ds_read_b64_tr_b16 v[50:51], v3 offset:14848
    v_mfma_f32_16x16x32_bf16 v[92:95], v[52:55], v[12:15], v[92:95]
    ds_read_b128 v[36:39], v2 offset:6144
    v_mfma_f32_16x16x32_bf16 v[108:111], v[52:55], v[16:19], v[108:111]
    s_setprio 0
    buffer_load_dwordx4 v238, s[8:11], s43 offen offset:2048 lds
    s_setprio 2
    v_mfma_f32_16x16x32_bf16 v[124:127], v[52:55], v[20:23], v[124:127]
    s_waitcnt lgkmcnt(12)
    ds_read_b64_tr_b16 v[52:53], v4 offset:14336
    v_mfma_f32_16x16x32_bf16 v[128:131], v[8:11], v[56:59], v[128:131]
    ds_read_b64_tr_b16 v[54:55], v4 offset:14848
    v_mfma_f32_16x16x32_bf16 v[132:135], v[12:15], v[56:59], v[132:135]
    s_add_u32 m0, s50, 3072
    s_setprio 0
    buffer_load_dwordx4 v239, s[8:11], s43 offen offset:0 lds
    s_setprio 2
    v_mfma_f32_16x16x32_bf16 v[144:147], v[16:19], v[56:59], v[144:147]
    v_mfma_f32_16x16x32_bf16 v[148:151], v[20:23], v[56:59], v[148:151]
    s_waitcnt lgkmcnt(12)
    ds_read_b64_tr_b16 v[56:57], v3 offset:16384
    v_mfma_f32_16x16x32_bf16 v[136:139], v[8:11], v[60:63], v[136:139]
    ds_read_b64_tr_b16 v[58:59], v3 offset:16896
    v_mfma_f32_16x16x32_bf16 v[140:143], v[12:15], v[60:63], v[140:143]
    s_setprio 0
    buffer_load_dwordx4 v240, s[8:11], s43 offen offset:1024 lds
    s_setprio 2
    v_mfma_f32_16x16x32_bf16 v[152:155], v[16:19], v[60:63], v[152:155]
    v_mfma_f32_16x16x32_bf16 v[156:159], v[20:23], v[60:63], v[156:159]
    s_waitcnt lgkmcnt(11)
    ds_read_b64_tr_b16 v[60:61], v4 offset:16384
    v_mfma_f32_16x16x32_bf16 v[64:67], v[40:43], v[24:27], v[64:67]
    s_waitcnt lgkmcnt(11)
    ds_read_b64_tr_b16 v[62:63], v4 offset:16896
    s_setprio 0
    buffer_load_dwordx4 v241, s[8:11], s43 offen offset:2048 lds
    s_setprio 2
    v_mfma_f32_16x16x32_bf16 v[80:83], v[40:43], v[28:31], v[80:83]
    s_waitcnt lgkmcnt(9)
    s_add_u32 s17, s17, 1
    s_add_u32 s45, s45, 1
    v_mfma_f32_16x16x32_bf16 v[96:99], v[40:43], v[32:35], v[96:99]
    s_waitcnt lgkmcnt(6)
    s_cmp_eq_u32 s45, 3
    s_cselect_b32 s3, 0xfffec000, s31
    v_mfma_f32_16x16x32_bf16 v[112:115], v[40:43], v[36:39], v[112:115]
    s_cselect_b32 s45, 0, s45
    v_add_u32 v3, s3, v3
    v_mfma_f32_16x16x32_bf16 v[68:71], v[44:47], v[24:27], v[68:71]
    v_add_u32 v1, s3, v1
    v_add_u32 v4, s3, v4
    v_mfma_f32_16x16x32_bf16 v[84:87], v[44:47], v[28:31], v[84:87]
    v_add_u32 v2, s3, v2
    s_waitcnt vmcnt(10) lgkmcnt(0)
    ds_add_u32 v254, v255
    s_add_u32 s48, s48, 4
    v_mfma_f32_16x16x32_bf16 v[100:103], v[44:47], v[32:35], v[100:103]
    ds_read_b32 v6, v254
    s_and_b32 s44, s62, 15
    s_lshr_b64 s[62:63], s[62:63], 4
    s_add_u32 s50, s41, s57
    v_mfma_f32_16x16x32_bf16 v[116:119], v[44:47], v[36:39], v[116:119]
    s_lshl_b32 s42, s44, 7
    s_mul_i32 s43, s44, 393216
    s_add_u32 m0, s40, s57
    v_mfma_f32_16x16x32_bf16 v[72:75], v[48:51], v[24:27], v[72:75]
    s_waitcnt lgkmcnt(0)
    v_cmp_gt_u32 vcc, s48, v6
    s_cbranch_vccnz L_ys_a
L_ysd_a:
    v_mfma_f32_16x16x32_bf16 v[88:91], v[48:51], v[28:31], v[88:91]
    ds_read_b64_tr_b16 v[40:41], v3 offset:0
    v_mfma_f32_16x16x32_bf16 v[104:107], v[48:51], v[32:35], v[104:107]
    ds_read_b64_tr_b16 v[42:43], v3 offset:512
    s_setprio 0
    buffer_load_dwordx4 v232, s[4:7], s42 offen offset:0 lds
    s_setprio 2
    v_mfma_f32_16x16x32_bf16 v[120:123], v[48:51], v[36:39], v[120:123]
    ds_read_b128 v[8:11], v1 offset:0
    v_mfma_f32_16x16x32_bf16 v[76:79], v[52:55], v[24:27], v[76:79]
    ds_read_b128 v[12:15], v1 offset:2048
    s_add_u32 s57, s57, s3
    v_mfma_f32_16x16x32_bf16 v[92:95], v[52:55], v[28:31], v[92:95]
    ds_read_b128 v[16:19], v1 offset:4096
    v_mfma_f32_16x16x32_bf16 v[108:111], v[52:55], v[32:35], v[108:111]
    ds_read_b128 v[20:23], v1 offset:6144
    v_mfma_f32_16x16x32_bf16 v[124:127], v[52:55], v[36:39], v[124:127]
    ds_read_b64_tr_b16 v[44:45], v4 offset:0
    s_setprio 0
    buffer_load_dwordx4 v233, s[4:7], s42 offen offset:1024 lds
    s_setprio 2
    v_mfma_f32_16x16x32_bf16 v[128:131], v[24:27], v[56:59], v[128:131]
    ds_read_b64_tr_b16 v[46:47], v4 offset:512
    v_mfma_f32_16x16x32_bf16 v[132:135], v[28:31], v[56:59], v[132:135]
    ds_read_b64_tr_b16 v[48:49], v3 offset:2048
    v_mfma_f32_16x16x32_bf16 v[144:147], v[32:35], v[56:59], v[144:147]
    ds_read_b64_tr_b16 v[50:51], v3 offset:2560
    v_mfma_f32_16x16x32_bf16 v[148:151], v[36:39], v[56:59], v[148:151]
    ds_read_b64_tr_b16 v[52:53], v4 offset:2048
    v_mfma_f32_16x16x32_bf16 v[136:139], v[24:27], v[60:63], v[136:139]
    ds_read_b64_tr_b16 v[54:55], v4 offset:2560
    s_setprio 0
    buffer_load_dwordx4 v234, s[4:7], s42 offen offset:2048 lds
    s_setprio 2
    v_mfma_f32_16x16x32_bf16 v[140:143], v[28:31], v[60:63], v[140:143]
    ds_read_b64_tr_b16 v[56:57], v3 offset:4096
    v_mfma_f32_16x16x32_bf16 v[152:155], v[32:35], v[60:63], v[152:155]
    ds_read_b64_tr_b16 v[58:59], v3 offset:4608
    s_cmp_lt_u32 s17, 13
    v_mfma_f32_16x16x32_bf16 v[156:159], v[36:39], v[60:63], v[156:159]
    s_waitcnt lgkmcnt(11)
    ds_read_b64_tr_b16 v[60:61], v4 offset:4096
    s_cbranch_scc1 L_y_loop
    v_mfma_f32_16x16x32_bf16 v[64:67], v[40:43], v[8:11], v[64:67]
    s_waitcnt lgkmcnt(11)
    ds_read_b64_tr_b16 v[62:63], v4 offset:4608
    v_mfma_f32_16x16x32_bf16 v[80:83], v[40:43], v[12:15], v[80:83]
    s_waitcnt lgkmcnt(11)
    ds_read_b128 v[24:27], v2 offset:0
    v_mfma_f32_16x16x32_bf16 v[96:99], v[40:43], v[16:19], v[96:99]
    s_waitcnt lgkmcnt(11)
    s_setprio 0
    buffer_load_dwordx4 v235, s[4:7], s42 offen offset:3072 lds
    s_setprio 2
    v_mfma_f32_16x16x32_bf16 v[112:115], v[40:43], v[20:23], v[112:115]
    s_waitcnt lgkmcnt(9)
    ds_read_b64_tr_b16 v[40:41], v3 offset:12288
    v_mfma_f32_16x16x32_bf16 v[68:71], v[44:47], v[8:11], v[68:71]
    ds_read_b64_tr_b16 v[42:43], v3 offset:12800
    v_mfma_f32_16x16x32_bf16 v[84:87], v[44:47], v[12:15], v[84:87]
    ds_read_b128 v[28:31], v2 offset:2048
    v_mfma_f32_16x16x32_bf16 v[100:103], v[44:47], v[16:19], v[100:103]
    s_mov_b32 m0, s50
    s_setprio 0
    buffer_load_dwordx4 v236, s[8:11], s43 offen offset:0 lds
    s_setprio 2
    v_mfma_f32_16x16x32_bf16 v[116:119], v[44:47], v[20:23], v[116:119]
    s_waitcnt lgkmcnt(10)
    ds_read_b64_tr_b16 v[44:45], v4 offset:12288
    v_mfma_f32_16x16x32_bf16 v[72:75], v[48:51], v[8:11], v[72:75]
    ds_read_b64_tr_b16 v[46:47], v4 offset:12800
    v_mfma_f32_16x16x32_bf16 v[88:91], v[48:51], v[12:15], v[88:91]
    ds_read_b128 v[32:35], v2 offset:4096
    v_mfma_f32_16x16x32_bf16 v[104:107], v[48:51], v[16:19], v[104:107]
    s_setprio 0
    buffer_load_dwordx4 v237, s[8:11], s43 offen offset:1024 lds
    s_setprio 2
    v_mfma_f32_16x16x32_bf16 v[120:123], v[48:51], v[20:23], v[120:123]
    s_waitcnt lgkmcnt(11)
    ds_read_b64_tr_b16 v[48:49], v3 offset:14336
    v_mfma_f32_16x16x32_bf16 v[76:79], v[52:55], v[8:11], v[76:79]
    ds_read_b64_tr_b16 v[50:51], v3 offset:14848
    v_mfma_f32_16x16x32_bf16 v[92:95], v[52:55], v[12:15], v[92:95]
    ds_read_b128 v[36:39], v2 offset:6144
    v_mfma_f32_16x16x32_bf16 v[108:111], v[52:55], v[16:19], v[108:111]
    s_setprio 0
    buffer_load_dwordx4 v238, s[8:11], s43 offen offset:2048 lds
    s_setprio 2
    v_mfma_f32_16x16x32_bf16 v[124:127], v[52:55], v[20:23], v[124:127]
    s_waitcnt lgkmcnt(12)
    ds_read_b64_tr_b16 v[52:53], v4 offset:14336
    v_mfma_f32_16x16x32_bf16 v[128:131], v[8:11], v[56:59], v[128:131]
    ds_read_b64_tr_b16 v[54:55], v4 offset:14848
    v_mfma_f32_16x16x32_bf16 v[132:135], v[12:15], v[56:59], v[132:135]
    s_add_u32 m0, s50, 3072
    s_setprio 0
    buffer_load_dwordx4 v239, s[8:11], s43 offen offset:0 lds
    s_setprio 2
    v_mfma_f32_16x16x32_bf16 v[144:147], v[16:19], v[56:59], v[144:147]
    v_mfma_f32_16x16x32_bf16 v[148:151], v[20:23], v[56:59], v[148:151]
    s_waitcnt lgkmcnt(12)
    ds_read_b64_tr_b16 v[56:57], v3 offset:16384
    v_mfma_f32_16x16x32_bf16 v[136:139], v[8:11], v[60:63], v[136:139]
    ds_read_b64_tr_b16 v[58:59], v3 offset:16896
    v_mfma_f32_16x16x32_bf16 v[140:143], v[12:15], v[60:63], v[140:143]
    s_setprio 0
    buffer_load_dwordx4 v240, s[8:11], s43 offen offset:1024 lds
    s_setprio 2
    v_mfma_f32_16x16x32_bf16 v[152:155], v[16:19], v[60:63], v[152:155]
    v_mfma_f32_16x16x32_bf16 v[156:159], v[20:23], v[60:63], v[156:159]
    s_waitcnt lgkmcnt(11)
    ds_read_b64_tr_b16 v[60:61], v4 offset:16384
    v_mfma_f32_16x16x32_bf16 v[64:67], v[40:43], v[24:27], v[64:67]
    s_waitcnt lgkmcnt(11)
    ds_read_b64_tr_b16 v[62:63], v4 offset:16896
    s_setprio 0
    buffer_load_dwordx4 v241, s[8:11], s43 offen offset:2048 lds
    s_setprio 2
    v_mfma_f32_16x16x32_bf16 v[80:83], v[40:43], v[28:31], v[80:83]
    s_waitcnt lgkmcnt(9)
    s_add_u32 s17, s17, 1
    s_add_u32 s45, s45, 1
    v_mfma_f32_16x16x32_bf16 v[96:99], v[40:43], v[32:35], v[96:99]
    s_waitcnt lgkmcnt(6)
    s_cmp_eq_u32 s45, 3
    s_cselect_b32 s3, 0xfffec000, s31
    v_mfma_f32_16x16x32_bf16 v[112:115], v[40:43], v[36:39], v[112:115]
    s_cselect_b32 s45, 0, s45
    v_add_u32 v3, s3, v3
    v_mfma_f32_16x16x32_bf16 v[68:71], v[44:47], v[24:27], v[68:71]
    v_add_u32 v1, s3, v1
    v_add_u32 v4, s3, v4
    v_mfma_f32_16x16x32_bf16 v[84:87], v[44:47], v[28:31], v[84:87]
    v_add_u32 v2, s3, v2
    s_waitcnt vmcnt(10) lgkmcnt(0)
    ds_add_u32 v254, v255
    s_add_u32 s48, s48, 4
    v_mfma_f32_16x16x32_bf16 v[100:103], v[44:47], v[32:35], v[100:103]
    ds_read_b32 v6, v254
    v_mfma_f32_16x16x32_bf16 v[116:119], v[44:47], v[36:39], v[116:119]
    v_mfma_f32_16x16x32_bf16 v[72:75], v[48:51], v[24:27], v[72:75]
    s_waitcnt lgkmcnt(0)
    v_cmp_gt_u32 vcc, s48, v6
    s_cbranch_vccnz L_ys_c
L_ysd_c:
    v_mfma_f32_16x16x32_bf16 v[88:91], v[48:51], v[28:31], v[88:91]
    ds_read_b64_tr_b16 v[40:41], v3 offset:0
    v_mfma_f32_16x16x32_bf16 v[104:107], v[48:51], v[32:35], v[104:107]
    ds_read_b64_tr_b16 v[42:43], v3 offset:512
    v_mfma_f32_16x16x32_bf16 v[120:123], v[48:51], v[36:39], v[120:123]
    ds_read_b128 v[8:11], v1 offset:0
    v_mfma_f32_16x16x32_bf16 v[76:79], v[52:55], v[24:27], v[76:79]
    ds_read_b128 v[12:15], v1 offset:2048
    v_mfma_f32_16x16x32_bf16 v[92:95], v[52:55], v[28:31], v[92:95]
    ds_read_b128 v[16:19], v1 offset:4096
    v_mfma_f32_16x16x32_bf16 v[108:111], v[52:55], v[32:35], v[108:111]
    ds_read_b128 v[20:23], v1 offset:6144
    v_mfma_f32_16x16x32_bf16 v[124:127], v[52:55], v[36:39], v[124:127]
    ds_read_b64_tr_b16 v[44:45], v4 offset:0
    v_mfma_f32_16x16x32_bf16 v[128:131], v[24:27], v[56:59], v[128:131]
    ds_read_b64_tr_b16 v[46:47], v4 offset:512
    v_mfma_f32_16x16x32_bf16 v[132:135], v[28:31], v[56:59], v[132:135]
    ds_read_b64_tr_b16 v[48:49], v3 offset:2048
    v_mfma_f32_16x16x32_bf16 v[144:147], v[32:35], v[56:59], v[144:147]
    ds_read_b64_tr_b16 v[50:51], v3 offset:2560
    v_mfma_f32_16x16x32_bf16 v[148:151], v[36:39], v[56:59], v[148:151]
    ds_read_b64_tr_b16 v[52:53], v4 offset:2048
    v_mfma_f32_16x16x32_bf16 v[136:139], v[24:27], v[60:63], v[136:139]
    ds_read_b64_tr_b16 v[54:55], v4 offset:2560
    v_mfma_f32_16x16x32_bf16 v[140:143], v[28:31], v[60:63], v[140:143]
    ds_read_b64_tr_b16 v[56:57], v3 offset:4096
    v_mfma_f32_16x16x32_bf16 v[152:155], v[32:35], v[60:63], v[152:155]
    ds_read_b64_tr_b16 v[58:59], v3 offset:4608
    v_mfma_f32_16x16x32_bf16 v[156:159], v[36:39], v[60:63], v[156:159]
    s_waitcnt lgkmcnt(11)
    ds_read_b64_tr_b16 v[60:61], v4 offset:4096
.p2align 6
L_y_loop2:
    v_mfma_f32_16x16x32_bf16 v[64:67], v[40:43], v[8:11], v[64:67]
    s_waitcnt lgkmcnt(11)
    ds_read_b64_tr_b16 v[62:63], v4 offset:4608
    v_mfma_f32_16x16x32_bf16 v[80:83], v[40:43], v[12:15], v[80:83]
    s_waitcnt lgkmcnt(11)
    ds_read_b128 v[24:27], v2 offset:0
    v_mfma_f32_16x16x32_bf16 v[96:99], v[40:43], v[16:19], v[96:99]
    s_waitcnt lgkmcnt(11)
    v_mfma_f32_16x16x32_bf16 v[112:115], v[40:43], v[20:23], v[112:115]
    s_waitcnt lgkmcnt(9)
    ds_read_b64_tr_b16 v[40:41], v3 offset:12288
    v_mfma_f32_16x16x32_bf16 v[68:71], v[44:47], v[8:11], v[68:71]
    ds_read_b64_tr_b16 v[42:43], v3 offset:12800
    v_mfma_f32_16x16x32_bf16 v[84:87], v[44:47], v[12:15], v[84:87]
    ds_read_b128 v[28:31], v2 offset:2048
    v_mfma_f32_16x16x32_bf16 v[100:103], v[44:47], v[16:19], v[100:103]
    v_mfma_f32_16x16x32_bf16 v[116:119], v[44:47], v[20:23], v[116:119]
    s_waitcnt lgkmcnt(10)
    ds_read_b64_tr_b16 v[44:45], v4 offset:12288
    v_mfma_f32_16x16x32_bf16 v[72:75], v[48:51], v[8:11], v[72:75]
    ds_read_b64_tr_b16 v[46:47], v4 offset:12800
    v_mfma_f32_16x16x32_bf16 v[88:91], v[48:51], v[12:15], v[88:91]
    ds_read_b128 v[32:35], v2 offset:4096
    v_mfma_f32_16x16x32_bf16 v[104:107], v[48:51], v[16:19], v[104:107]
    v_mfma_f32_16x16x32_bf16 v[120:123], v[48:51], v[20:23], v[120:123]
    s_waitcnt lgkmcnt(11)
    ds_read_b64_tr_b16 v[48:49], v3 offset:14336
    v_mfma_f32_16x16x32_bf16 v[76:79], v[52:55], v[8:11], v[76:79]
    ds_read_b64_tr_b16 v[50:51], v3 offset:14848
    v_mfma_f32_16x16x32_bf16 v[92:95], v[52:55], v[12:15], v[92:95]
    ds_read_b128 v[36:39], v2 offset:6144
    v_mfma_f32_16x16x32_bf16 v[108:111], v[52:55], v[16:19], v[108:111]
    v_mfma_f32_16x16x32_bf16 v[124:127], v[52:55], v[20:23], v[124:127]
    s_waitcnt lgkmcnt(12)
    ds_read_b64_tr_b16 v[52:53], v4 offset:14336
    v_mfma_f32_16x16x32_bf16 v[128:131], v[8:11], v[56:59], v[128:131]
    ds_read_b64_tr_b16 v[54:55], v4 offset:14848
    v_mfma_f32_16x16x32_bf16 v[132:135], v[12:15], v[56:59], v[132:135]
    v_mfma_f32_16x16x32_bf16 v[144:147], v[16:19], v[56:59], v[144:147]
    v_mfma_f32_16x16x32_bf16 v[148:151], v[20:23], v[56:59], v[148:151]
    s_waitcnt lgkmcnt(12)
    ds_read_b64_tr_b16 v[56:57], v3 offset:16384
    v_mfma_f32_16x16x32_bf16 v[136:139], v[8:11], v[60:63], v[136:139]
    ds_read_b64_tr_b16 v[58:59], v3 offset:16896
    v_mfma_f32_16x16x32_bf16 v[140:143], v[12:15], v[60:63], v[140:143]
    v_mfma_f32_16x16x32_bf16 v[152:155], v[16:19], v[60:63], v[152:155]
    v_mfma_f32_16x16x32_bf16 v[156:159], v[20:23], v[60:63], v[156:159]
    s_waitcnt lgkmcnt(11)
    ds_read_b64_tr_b16 v[60:61], v4 offset:16384
    v_mfma_f32_16x16x32_bf16 v[64:67], v[40:43], v[24:27], v[64:67]
    s_waitcnt lgkmcnt(11)
    ds_read_b64_tr_b16 v[62:63], v4 offset:16896
    v_mfma_f32_16x16x32_bf16 v[80:83], v[40:43], v[28:31], v[80:83]
    s_waitcnt lgkmcnt(9)
    s_add_u32 s17, s17, 1
    s_add_u32 s45, s45, 1
    v_mfma_f32_16x16x32_bf16 v[96:99], v[40:43], v[32:35], v[96:99]
    s_waitcnt lgkmcnt(6)
    s_cmp_eq_u32 s45, 3
    s_cselect_b32 s3, 0xfffec000, s31
    v_mfma_f32_16x16x32_bf16 v[112:115], v[40:43], v[36:39], v[112:115]
    s_cselect_b32 s45, 0, s45
    v_add_u32 v3, s3, v3
    v_mfma_f32_16x16x32_bf16 v[68:71], v[44:47], v[24:27], v[68:71]
    v_add_u32 v1, s3, v1
    v_add_u32 v4, s3, v4
    v_mfma_f32_16x16x32_bf16 v[84:87], v[44:47], v[28:31], v[84:87]
    v_add_u32 v2, s3, v2
    s_waitcnt vmcnt(0) lgkmcnt(0)
    ds_add_u32 v254, v255
    s_add_u32 s48, s48, 4
    v_mfma_f32_16x16x32_bf16 v[100:103], v[44:47], v[32:35], v[100:103]
    ds_read_b32 v6, v254
    v_mfma_f32_16x16x32_bf16 v[116:119], v[44:47], v[36:39], v[116:119]
    v_mfma_f32_16x16x32_bf16 v[72:75], v[48:51], v[24:27], v[72:75]
    s_waitcnt lgkmcnt(0)
    v_cmp_gt_u32 vcc, s48, v6
    s_cbranch_vccnz L_ys_b
L_ysd_b:
    v_mfma_f32_16x16x32_bf16 v[88:91], v[48:51], v[28:31], v[88:91]
    ds_read_b64_tr_b16 v[40:41], v3 offset:0
    v_mfma_f32_16x16x32_bf16 v[104:107], v[48:51], v[32:35], v[104:107]
    ds_read_b64_tr_b16 v[42:43], v3 offset:512
    v_mfma_f32_16x16x32_bf16 v[120:123], v[48:51], v[36:39], v[120:123]
    ds_read_b128 v[8:11], v1 offset:0
    v_mfma_f32_16x16x32_bf16 v[76:79], v[52:55], v[24:27], v[76:79]
    ds_read_b128 v[12:15], v1 offset:2048
    v_mfma_f32_16x16x32_bf16 v[92:95], v[52:55], v[28:31], v[92:95]
    ds_read_b128 v[16:19], v1 offset:4096
    v_mfma_f32_16x16x32_bf16 v[108:111], v[52:55], v[32:35], v[108:111]
    ds_read_b128 v[20:23], v1 offset:6144
    v_mfma_f32_16x16x32_bf16 v[124:127], v[52:55], v[36:39], v[124:127]
    ds_read_b64_tr_b16 v[44:45], v4 offset:0
    v_mfma_f32_16x16x32_bf16 v[128:131], v[24:27], v[56:59], v[128:131]
    ds_read_b64_tr_b16 v[46:47], v4 offset:512
    v_mfma_f32_16x16x32_bf16 v[132:135], v[28:31], v[56:59], v[132:135]
    ds_read_b64_tr_b16 v[48:49], v3 offset:2048
    v_mfma_f32_16x16x32_bf16 v[144:147], v[32:35], v[56:59], v[144:147]
    ds_read_b64_tr_b16 v[50:51], v3 offset:2560
    v_mfma_f32_16x16x32_bf16 v[148:151], v[36:39], v[56:59], v[148:151]
    ds_read_b64_tr_b16 v[52:53], v4 offset:2048
    v_mfma_f32_16x16x32_bf16 v[136:139], v[24:27], v[60:63], v[136:139]
    ds_read_b64_tr_b16 v[54:55], v4 offset:2560
    v_mfma_f32_16x16x32_bf16 v[140:143], v[28:31], v[60:63], v[140:143]
    ds_read_b64_tr_b16 v[56:57], v3 offset:4096
    v_mfma_f32_16x16x32_bf16 v[152:155], v[32:35], v[60:63], v[152:155]
    ds_read_b64_tr_b16 v[58:59], v3 offset:4608
    s_cmp_lt_u32 s17, 16
    v_mfma_f32_16x16x32_bf16 v[156:159], v[36:39], v[60:63], v[156:159]
    s_waitcnt lgkmcnt(11)
    ds_read_b64_tr_b16 v[60:61], v4 offset:4096
    s_cbranch_scc1 L_y_loop2
    s_mul_i32 s38, s37, 49152
    s_lshl_b32 s39, s36, 13
    s_add_u32 s39, s39, s38
    s_add_u32 s40, s39, 32768
    s_lshl_b32 s41, s59, 12
    s_add_u32 s41, s41, 98304
    s_load_dwordx2 s[20:21], s[0:1], 16
    s_load_dwordx2 s[22:23], s[0:1], 40
    s_waitcnt lgkmcnt(0)
    v_lshlrev_b32 v1, 4, v0
    v_add_u32 v8, s41, v5
    v_add_u32 v9, s40, v5
    v_and_b32 v10, 3, v0
    v_bfe_u32 v11, v0, 2, 2
    v_lshl_add_u32 v10, v11, 3, v10
    v_lshrrev_b32 v11, 4, v0
    v_lshlrev_b32 v10, 4, v10
    v_lshl_add_u32 v10, v11, 9, v10
    v_add_u32 v10, s40, v10
    v_add_u32 v11, s40, v1
    v_cvt_pk_bf16_f32 v72, v72, v73
    v_cvt_pk_bf16_f32 v73, v74, v75
    v_cvt_pk_bf16_f32 v74, v76, v77
    v_cvt_pk_bf16_f32 v75, v78, v79
    ds_write_b128 v10, v[72:75] offset:0
    v_cvt_pk_bf16_f32 v88, v88, v89
    v_cvt_pk_bf16_f32 v89, v90, v91
    v_cvt_pk_bf16_f32 v90, v92, v93
    v_cvt_pk_bf16_f32 v91, v94, v95
    ds_write_b128 v10, v[88:91] offset:64
    v_cvt_pk_bf16_f32 v128, v128, v129
    v_cvt_pk_bf16_f32 v129, v130, v131
    v_cvt_pk_bf16_f32 v130, v132, v133
    v_cvt_pk_bf16_f32 v131, v134, v135
    ds_write_b128 v9, v[128:131] offset:2048
    v_cvt_pk_bf16_f32 v136, v136, v137
    v_cvt_pk_bf16_f32 v137, v138, v139
    v_cvt_pk_bf16_f32 v138, v140, v141
    v_cvt_pk_bf16_f32 v139, v142, v143
    ds_write_b128 v9, v[136:139] offset:2304
    ds_read_b128 v[192:195], v11 offset:0
    ds_read_b128 v[196:199], v11 offset:1024
    ds_read_b128 v[200:203], v11 offset:2048
    ds_read_b128 v[204:207], v11 offset:3072
    v_cvt_pk_bf16_f32 v104, v104, v105
    v_cvt_pk_bf16_f32 v105, v106, v107
    v_cvt_pk_bf16_f32 v106, v108, v109
    v_cvt_pk_bf16_f32 v107, v110, v111
    ds_write_b128 v10, v[104:107] offset:4096
    v_cvt_pk_bf16_f32 v120, v120, v121
    v_cvt_pk_bf16_f32 v121, v122, v123
    v_cvt_pk_bf16_f32 v122, v124, v125
    v_cvt_pk_bf16_f32 v123, v126, v127
    ds_write_b128 v10, v[120:123] offset:4160
    v_cvt_pk_bf16_f32 v144, v144, v145
    v_cvt_pk_bf16_f32 v145, v146, v147
    v_cvt_pk_bf16_f32 v146, v148, v149
    v_cvt_pk_bf16_f32 v147, v150, v151
    ds_write_b128 v9, v[144:147] offset:6144
    v_cvt_pk_bf16_f32 v152, v152, v153
    v_cvt_pk_bf16_f32 v153, v154, v155
    v_cvt_pk_bf16_f32 v154, v156, v157
    v_cvt_pk_bf16_f32 v155, v158, v159
    ds_write_b128 v9, v[152:155] offset:6400
    ds_read_b128 v[208:211], v11 offset:4096
    ds_read_b128 v[212:215], v11 offset:5120
    ds_read_b128 v[216:219], v11 offset:6144
    ds_read_b128 v[220:223], v11 offset:7168
    v_mul_f32 v64, s67, v64
    v_mul_f32 v65, s67, v65
    v_mul_f32 v66, s67, v66
    v_mul_f32 v67, s67, v67
    v_mul_f32 v68, s67, v68
    v_mul_f32 v69, s67, v69
    v_mul_f32 v70, s67, v70
    v_mul_f32 v71, s67, v71
    v_cvt_pk_bf16_f32 v64, v64, v65
    v_cvt_pk_bf16_f32 v65, v66, v67
    v_cvt_pk_bf16_f32 v66, v68, v69
    v_cvt_pk_bf16_f32 v67, v70, v71
    ds_write_b128 v8, v[64:67] offset:0
    s_add_u32 s66, s65, 4096
    s_waitcnt lgkmcnt(1)
    buffer_store_dwordx4 v[192:195], v1, s[12:15], s65 offen offset:0 sc1
    buffer_store_dwordx4 v[196:199], v1, s[12:15], s65 offen offset:1024 sc1
    buffer_store_dwordx4 v[200:203], v1, s[12:15], s65 offen offset:2048 sc1
    buffer_store_dwordx4 v[204:207], v1, s[12:15], s65 offen offset:3072 sc1
    buffer_store_dwordx4 v[208:211], v1, s[12:15], s66 offen offset:0 sc1
    buffer_store_dwordx4 v[212:215], v1, s[12:15], s66 offen offset:1024 sc1
    buffer_store_dwordx4 v[216:219], v1, s[12:15], s66 offen offset:2048 sc1
    buffer_store_dwordx4 v[220:223], v1, s[12:15], s66 offen offset:3072 sc1
    v_mul_f32 v80, s67, v80
    v_mul_f32 v81, s67, v81
    v_mul_f32 v82, s67, v82
    v_mul_f32 v83, s67, v83
    v_mul_f32 v84, s67, v84
    v_mul_f32 v85, s67, v85
    v_mul_f32 v86, s67, v86
    v_mul_f32 v87, s67, v87
    v_cvt_pk_bf16_f32 v80, v80, v81
    v_cvt_pk_bf16_f32 v81, v82, v83
    v_cvt_pk_bf16_f32 v82, v84, v85
    v_cvt_pk_bf16_f32 v83, v86, v87
    ds_write_b128 v8, v[80:83] offset:256
    v_mul_f32 v96, s67, v96
    v_mul_f32 v97, s67, v97
    v_mul_f32 v98, s67, v98
    v_mul_f32 v99, s67, v99
    v_mul_f32 v100, s67, v100
    v_mul_f32 v101, s67, v101
    v_mul_f32 v102, s67, v102
    v_mul_f32 v103, s67, v103
    v_cvt_pk_bf16_f32 v96, v96, v97
    v_cvt_pk_bf16_f32 v97, v98, v99
    v_cvt_pk_bf16_f32 v98, v100, v101
    v_cvt_pk_bf16_f32 v99, v102, v103
    ds_write_b128 v8, v[96:99] offset:2048
    v_mul_f32 v112, s67, v112
    v_mul_f32 v113, s67, v113
    v_mul_f32 v114, s67, v114
    v_mul_f32 v115, s67, v115
    v_mul_f32 v116, s67, v116
    v_mul_f32 v117, s67, v117
    v_mul_f32 v118, s67, v118
    v_mul_f32 v119, s67, v119
    v_cvt_pk_bf16_f32 v112, v112, v113
    v_cvt_pk_bf16_f32 v113, v114, v115
    v_cvt_pk_bf16_f32 v114, v116, v117
    v_cvt_pk_bf16_f32 v115, v118, v119
    ds_write_b128 v8, v[112:115] offset:2304
    v_add_u32 v11, s41, v1
    ds_read_b128 v[160:163], v11 offset:0
    ds_read_b128 v[164:167], v11 offset:1024
    ds_read_b128 v[168:171], v11 offset:2048
    ds_read_b128 v[172:175], v11 offset:3072
    s_mov_b32 s42, s65
    s_mov_b32 s62, s68
    s_mov_b32 s63, s69
    s_cmp_lg_u32 s70, 0
    s_cbranch_scc0 L_non_y
L_nond_y:
    s_lshl_b32 s49, s34, 2
    s_add_u32 s49, s49, s59
    s_lshl_b32 s49, s49, 11
    s_add_u32 s49, s49, 0
    s_lshl_b32 s32, s33, 7
    s_add_u32 s32, s32, s49
    s_mov_b32 s46, 0x4b800000
    s_mov_b32 s47, 0x42b00000
    v_mov_b32 v4, 0xdddddddd
    v_and_b32 v2, 7, v0
    v_mov_b32 v3, 0x3f803f80
    v_cmp_eq_u32 vcc, 0, v2
    v_mov_b32 v5, 0xff800000
    s_nop 0
    v_cndmask_b32 v8, 0, v3, vcc
    v_cndmask_b32 v9, 0, v3, vcc
    v_cmp_eq_u32 vcc, 4, v2
    s_nop 1
    v_cndmask_b32 v10, 0, v3, vcc
    v_cndmask_b32 v11, 0, v3, vcc
    s_mov_b32 s64, 0x0
    s_mov_b32 s65, 0xffff
    s_mov_b32 s66, 0x1
    s_mov_b32 s67, 0x1ffff
    s_mov_b32 s68, 0x3
    s_mov_b32 s69, 0x3ffff
    s_mov_b32 s70, 0x7
    s_mov_b32 s71, 0x7ffff
    s_mov_b32 s72, 0xf
    s_mov_b32 s73, 0xfffff
    s_mov_b32 s74, 0x1f
    s_mov_b32 s75, 0x1fffff
    s_mov_b32 s76, 0x3f
    s_mov_b32 s77, 0x3fffff
    s_mov_b32 s78, 0x7f
    s_mov_b32 s79, 0x7fffff
    s_mov_b32 s80, 0xff
    s_mov_b32 s81, 0xffffff
    s_mov_b32 s82, 0x1ff
    s_mov_b32 s83, 0x1ffffff
    s_mov_b32 s84, 0x3ff
    s_mov_b32 s85, 0x3ffffff
    s_mov_b32 s86, 0x7ff
    s_mov_b32 s87, 0x7ffffff
    s_mov_b32 s88, 0xfff
    s_mov_b32 s89, 0xfffffff
    s_mov_b32 s90, 0x1fff
    s_mov_b32 s91, 0x1fffffff
    s_mov_b32 s92, 0x3fff
    s_mov_b32 s93, 0x3fffffff
    s_mov_b32 s94, 0x7fff
    s_mov_b32 s95, 0x7fffffff
    s_lshl_b32 s50, 1, s33
    s_lshr_b32 s51, s50, 1
    s_lshr_b32 s50, s50, 2
    s_or_b32 s51, s51, s50
    s_mov_b32 s56, 0
    s_waitcnt vmcnt(0)
    v_lshrrev_b32 v6, 1, v1
    v_mov_b32 v2, s62
    v_mov_b32 v3, s63
    s_mov_b64 exec, 0xffff
    buffer_store_dwordx2 v[2:3], v6, s[12:15], s32 offen sc1
    s_mov_b64 exec, -1
    s_bfe_u32 s30, s2, 0x20001
    s_lshl_b32 s30, s30, 2
    s_bfe_u32 s50, s2, 0x20003
    s_add_u32 s30, s30, s50
    s_and_b32 s31, s2, 1
    s_lshl_b32 s31, s31, 3
    s_lshr_b32 s50, s2, 5
    s_add_u32 s31, s31, s50
    s_and_b32 s44, s30, 3
    s_lshl_b32 s44, s44, 2
    s_add_u32 s44, s44, s59
    s_lshl_b32 s44, s44, 17
    s_lshl_b32 s50, s31, 7
    s_add_u32 s44, s44, s50
    v_lshlrev_b32 v224, 11, v0
    s_mov_b32 s4, s20
    s_mov_b32 s5, s21
    s_mov_b32 s6, 0x200000
    s_mov_b32 s7, 0x00020000
    s_setprio 0
    s_sleep 20
    s_mov_b32 s100, 262144
L_poll_a:
    v_lshlrev_b32 v2, 3, v1
    s_mov_b64 exec, 0xffff
    buffer_load_dwordx2 v[2:3], v2, s[12:15], s49 offen sc1
    s_waitcnt vmcnt(0)
    v_cmp_eq_u64 vcc, s[62:63], v[2:3]
    s_mov_b64 exec, -1
    s_nop 3
    s_or_b32 s56, s56, vcc_lo
    s_and_b32 s101, s56, s51
    s_cmp_eq_u32 s101, s51
    s_cbranch_scc1 L_polld_a
    s_sleep 32
    s_sub_u32 s100, s100, 1
    s_cbranch_scc0 L_poll_a
L_polld_a:
    s_cmp_lt_u32 s33, 1
    s_cbranch_scc1 L_y_nowin
    s_add_u32 m0, s39, 16384
    s_sub_u32 s50, s42, 16384
    buffer_load_dwordx4 v1, s[12:15], s50 offen offset:0 sc1 lds
    buffer_load_dwordx4 v1, s[12:15], s50 offen offset:1024 sc1 lds
    buffer_load_dwordx4 v1, s[12:15], s50 offen offset:2048 sc1 lds
    buffer_load_dwordx4 v1, s[12:15], s50 offen offset:3072 sc1 lds
    s_add_u32 m0, s39, 20480
    s_sub_u32 s50, s42, 12288
    buffer_load_dwordx4 v1, s[12:15], s50 offen offset:0 sc1 lds
    buffer_load_dwordx4 v1, s[12:15], s50 offen offset:1024 sc1 lds
    buffer_load_dwordx4 v1, s[12:15], s50 offen offset:2048 sc1 lds
    buffer_load_dwordx4 v1, s[12:15], s50 offen offset:3072 sc1 lds
    s_cmp_lt_u32 s33, 2
    s_cbranch_scc1 L_y_nowin
    s_add_u32 m0, s39, 0
    s_sub_u32 s50, s42, 32768
    buffer_load_dwordx4 v1, s[12:15], s50 offen offset:0 sc1 lds
    buffer_load_dwordx4 v1, s[12:15], s50 offen offset:1024 sc1 lds
    buffer_load_dwordx4 v1, s[12:15], s50 offen offset:2048 sc1 lds
    buffer_load_dwordx4 v1, s[12:15], s50 offen offset:3072 sc1 lds
    s_add_u32 m0, s39, 4096
    s_sub_u32 s50, s42, 28672
    buffer_load_dwordx4 v1, s[12:15], s50 offen offset:0 sc1 lds
    buffer_load_dwordx4 v1, s[12:15], s50 offen offset:1024 sc1 lds
    buffer_load_dwordx4 v1, s[12:15], s50 offen offset:2048 sc1 lds
    buffer_load_dwordx4 v1, s[12:15], s50 offen offset:3072 sc1 lds
L_y_nowin:
    s_setprio 2
    s_lshl_b32 s58, s33, 2
    s_lshl_b32 s50, s36, 1
    s_add_u32 s58, s58, s50
    s_lshl_b32 s41, s58, 5
    s_lshl_b32 s50, s34, 1
    s_add_u32 s41, s41, s50
    s_add_u32 s41, s41, s37
    s_lshl_b32 s41, s41, 11
    s_add_u32 s41, s41, 25165824
    s_mov_b32 s43, 0
    s_waitcnt vmcnt(0) lgkmcnt(0)
    v_mov_b32 v176, v160
    v_mov_b32 v177, v161
    v_mov_b32 v178, v162
    v_mov_b32 v179, v163
    v_mov_b32 v180, v164
    v_mov_b32 v181, v165
    v_mov_b32 v182, v166
    v_mov_b32 v183, v167
    ds_add_u32 v254, v255
    s_add_u32 s48, s48, 4
    s_mov_b32 s100, 4194304
L_spin_y3:
    ds_read_b32 v6, v254
    s_waitcnt lgkmcnt(0)
    v_cmp_le_u32 vcc, s48, v6
    s_cbranch_vccnz L_spind_y3
    s_sleep 4
    s_sub_u32 s100, s100, 1
    s_cbranch_scc0 L_spin_y3
L_spind_y3:
    s_setprio 2
L_ya_unit:
    v_mov_b32 v80, 0
    v_mov_b32 v81, 0
    v_mov_b32 v82, 0
    v_mov_b32 v83, 0
    v_mov_b32 v84, 0
    v_mov_b32 v85, 0
    v_mov_b32 v86, 0
    v_mov_b32 v87, 0
    v_mov_b32 v88, 0
    v_mov_b32 v89, 0
    v_mov_b32 v90, 0
    v_mov_b32 v91, 0
    v_mov_b32 v92, 0
    v_mov_b32 v93, 0
    v_mov_b32 v94, 0
    v_mov_b32 v95, 0
    v_mov_b32 v228, 0
    v_mov_b32 v229, 0
    v_mov_b32 v230, 0
    v_mov_b32 v231, 0
    v_add_u32 v208, s39, v1
    s_add_u32 s45, s58, 1
    s_cmp_lt_u32 s58, 8
    s_cselect_b32 s45, s45, 99
    s_cmp_eq_u32 s45, 1
    s_cselect_b32 s50, 4096, 0
    v_add_u32 v209, s50, v208
    ds_read_b128 v[192:195], v209 offset:28672
    ds_read_b128 v[196:199], v209 offset:29696
    s_waitcnt lgkmcnt(0)
    v_mfma_f32_32x32x16_bf16 v[16:31], v[192:195], v[176:179], 0
    v_mfma_f32_32x32x16_bf16 v[16:31], v[196:199], v[180:183], v[16:31]
    ds_read_b128 v[192:195], v208 offset:32768
    ds_read_b128 v[196:199], v208 offset:33792
    ds_read_b128 v[200:203], v209 offset:30720
    s_nop 12
    s_cmp_lg_u32 s45, 1
    s_cbranch_scc1 L_a_nofix0
    v_cndmask_b32 v16, v16, v5, s[64:65]
    v_cndmask_b32 v17, v17, v5, s[66:67]
    v_cndmask_b32 v18, v18, v5, s[68:69]
    v_cndmask_b32 v19, v19, v5, s[70:71]
    v_cndmask_b32 v20, v20, v5, s[72:73]
    v_cndmask_b32 v21, v21, v5, s[74:75]
    v_cndmask_b32 v22, v22, v5, s[76:77]
    v_cndmask_b32 v23, v23, v5, s[78:79]
    v_cndmask_b32 v24, v24, v5, s[80:81]
    v_cndmask_b32 v25, v25, v5, s[82:83]
    v_cndmask_b32 v26, v26, v5, s[84:85]
    v_cndmask_b32 v27, v27, v5, s[86:87]
    v_cndmask_b32 v28, v28, v5, s[88:89]
    v_cndmask_b32 v29, v29, v5, s[90:91]
    v_cndmask_b32 v30, v30, v5, s[92:93]
    v_cndmask_b32 v31, v31, v5, s[94:95]
L_a_nofix0:
    v_max3_f32 v2, v16, v17, v18
    v_max3_f32 v2, v2, v19, v20
    v_max3_f32 v2, v2, v21, v22
    v_max3_f32 v2, v2, v23, v24
    v_max3_f32 v2, v2, v25, v26
    v_max3_f32 v2, v2, v27, v28
    v_max3_f32 v2, v2, v29, v30
    v_max_f32 v2, v2, v31
    v_mov_b32 v3, v2
    s_nop 1
    v_permlane32_swap_b32 v2, v3
    s_nop 1
    v_max_f32 v2, v2, v3
    v_add_f32 v2, s47, v2
    v_sub_f32 v112, 0, v2
    v_mov_b32 v113, v112
    v_mov_b32 v114, v112
    v_mov_b32 v115, v112
    v_mov_b32 v116, v112
    v_mov_b32 v117, v112
    v_mov_b32 v118, v112
    v_mov_b32 v119, v112
    v_mov_b32 v120, v112
    v_mov_b32 v121, v112
    v_mov_b32 v122, v112
    v_mov_b32 v123, v112
    v_mov_b32 v124, v112
    v_mov_b32 v125, v112
    v_mov_b32 v126, v112
    v_mov_b32 v127, v112
    v_add_f32 v16, v112, v16
    v_add_f32 v17, v112, v17
    v_add_f32 v18, v112, v18
    v_add_f32 v19, v112, v19
    v_add_f32 v20, v112, v20
    v_add_f32 v21, v112, v21
    v_add_f32 v22, v112, v22
    v_add_f32 v23, v112, v23
    v_add_f32 v24, v112, v24
    v_add_f32 v25, v112, v25
    v_add_f32 v26, v112, v26
    v_add_f32 v27, v112, v27
    v_add_f32 v28, v112, v28
    v_add_f32 v29, v112, v29
    v_add_f32 v30, v112, v30
    v_add_f32 v31, v112, v31
    v_exp_f32 v16, v16
    v_exp_f32 v17, v17
    ds_read_b128 v[204:207], v209 offset:31744
    v_exp_f32 v18, v18
    v_exp_f32 v19, v19
    v_exp_f32 v20, v20
    s_waitcnt lgkmcnt(3)
    s_cmp_eq_u32 s45, 1
    s_cbranch_scc1 L_a_inv0
L_a_val0:
    v_cndmask_b32 v128, v112, v5, s[64:65]
    v_cndmask_b32 v129, v113, v5, s[66:67]
    v_cndmask_b32 v130, v114, v5, s[68:69]
    v_cndmask_b32 v131, v115, v5, s[70:71]
    v_cndmask_b32 v132, v116, v5, s[72:73]
    v_cndmask_b32 v133, v117, v5, s[74:75]
    v_cndmask_b32 v134, v118, v5, s[76:77]
    v_cndmask_b32 v135, v119, v5, s[78:79]
    v_cndmask_b32 v136, v120, v5, s[80:81]
    v_cndmask_b32 v137, v121, v5, s[82:83]
    v_cndmask_b32 v138, v122, v5, s[84:85]
    v_cndmask_b32 v139, v123, v5, s[86:87]
    v_cndmask_b32 v140, v124, v5, s[88:89]
    v_cndmask_b32 v141, v125, v5, s[90:91]
    v_cndmask_b32 v142, v126, v5, s[92:93]
    v_cndmask_b32 v143, v127, v5, s[94:95]
    s_nop 0
    v_exp_f32 v21, v21
    v_mfma_f32_32x32x16_bf16 v[32:47], v[192:195], v[176:179], v[128:143]
    s_waitcnt lgkmcnt(2)
    ds_read_b128 v[192:195], v208 offset:24576
    v_exp_f32 v22, v22
    v_exp_f32 v23, v23
    v_exp_f32 v24, v24
    v_mfma_f32_32x32x16_bf16 v[32:47], v[196:199], v[180:183], v[32:47]
    s_waitcnt lgkmcnt(2)
    ds_read_b128 v[196:199], v208 offset:25600
    v_exp_f32 v25, v25
    v_exp_f32 v26, v26
    v_exp_f32 v27, v27
    v_smfmac_f32_32x32x32_bf16 v[80:95], v[200:203], v[16:23], v4
    ds_read_b128 v[200:203], v208 offset:34816
    v_exp_f32 v28, v28
    v_exp_f32 v29, v29
    v_exp_f32 v30, v30
    v_smfmac_f32_16x16x64_bf16 v[228:231], v[8:11], v[16:23], v4
    s_waitcnt lgkmcnt(3)
    v_exp_f32 v31, v31
    v_exp_f32 v32, v32
    v_exp_f32 v33, v33
    v_smfmac_f32_32x32x32_bf16 v[80:95], v[204:207], v[24:31], v4
    ds_read_b128 v[204:207], v208 offset:35840
    v_exp_f32 v34, v34
    v_exp_f32 v35, v35
    v_exp_f32 v36, v36
    v_smfmac_f32_16x16x64_bf16 v[228:231], v[8:11], v[24:31], v4
    s_waitcnt lgkmcnt(3)
    s_cmp_eq_u32 s59, 0
    s_cbranch_scc1 L_a_wt1
L_a_wtd1:
    s_cmp_eq_u32 s45, 2
    s_cbranch_scc1 L_a_inv1
L_a_val1:
    v_exp_f32 v37, v37
    v_mfma_f32_32x32x16_bf16 v[16:31], v[192:195], v[176:179], v[112:127]
    s_waitcnt lgkmcnt(2)
    ds_read_b128 v[192:195], v208 offset:20480
    v_exp_f32 v38, v38
    v_exp_f32 v39, v39
    v_exp_f32 v40, v40
    v_mfma_f32_32x32x16_bf16 v[16:31], v[196:199], v[180:183], v[16:31]
    s_waitcnt lgkmcnt(2)
    ds_read_b128 v[196:199], v208 offset:21504
    v_exp_f32 v41, v41
    v_exp_f32 v42, v42
    v_exp_f32 v43, v43
    v_smfmac_f32_32x32x32_bf16 v[80:95], v[200:203], v[32:39], v4
    ds_read_b128 v[200:203], v208 offset:26624
    v_exp_f32 v44, v44
    v_exp_f32 v45, v45
    v_exp_f32 v46, v46
    v_smfmac_f32_16x16x64_bf16 v[228:231], v[8:11], v[32:39], v4
    s_waitcnt lgkmcnt(3)
    v_exp_f32 v47, v47
    v_exp_f32 v16, v16
    v_exp_f32 v17, v17
    v_smfmac_f32_32x32x32_bf16 v[80:95], v[204:207], v[40:47], v4
    ds_read_b128 v[204:207], v208 offset:27648
    v_exp_f32 v18, v18
    v_exp_f32 v19, v19
    v_exp_f32 v20, v20
    v_smfmac_f32_16x16x64_bf16 v[228:231], v[8:11], v[40:47], v4
    s_waitcnt lgkmcnt(3)
    s_cmp_eq_u32 s45, 3
    s_cbranch_scc1 L_a_inv2
L_a_val2:
    v_exp_f32 v21, v21
    v_mfma_f32_32x32x16_bf16 v[32:47], v[192:195], v[176:179], v[112:127]
    s_waitcnt lgkmcnt(2)
    ds_read_b128 v[192:195], v208 offset:16384
    v_exp_f32 v22, v22
    v_exp_f32 v23, v23
    v_exp_f32 v24, v24
    v_mfma_f32_32x32x16_bf16 v[32:47], v[196:199], v[180:183], v[32:47]
    s_waitcnt lgkmcnt(2)
    ds_read_b128 v[196:199], v208 offset:17408
    v_exp_f32 v25, v25
    v_exp_f32 v26, v26
    v_exp_f32 v27, v27
    v_smfmac_f32_32x32x32_bf16 v[80:95], v[200:203], v[16:23], v4
    ds_read_b128 v[200:203], v208 offset:22528
    v_exp_f32 v28, v28
    v_exp_f32 v29, v29
    v_cmp_lt_f32 vcc, s46, v228
    v_exp_f32 v30, v30
    v_smfmac_f32_16x16x64_bf16 v[228:231], v[8:11], v[16:23], v4
    s_waitcnt lgkmcnt(3)
    s_cbranch_vccnz L_resc_a2
L_back_a2:
    v_exp_f32 v31, v31
    v_exp_f32 v32, v32
    v_exp_f32 v33, v33
    v_smfmac_f32_32x32x32_bf16 v[80:95], v[204:207], v[24:31], v4
    ds_read_b128 v[204:207], v208 offset:23552
    v_exp_f32 v34, v34
    v_exp_f32 v35, v35
    v_exp_f32 v36, v36
    v_smfmac_f32_16x16x64_bf16 v[228:231], v[8:11], v[24:31], v4
    s_waitcnt lgkmcnt(3)
    s_cmp_eq_u32 s59, 1
    s_cbranch_scc1 L_a_wt3
L_a_wtd3:
    s_cmp_eq_u32 s45, 4
    s_cbranch_scc1 L_a_inv3
L_a_val3:
    v_exp_f32 v37, v37
    v_mfma_f32_32x32x16_bf16 v[16:31], v[192:195], v[176:179], v[112:127]
    s_waitcnt lgkmcnt(2)
    ds_read_b128 v[192:195], v208 offset:12288
    v_exp_f32 v38, v38
    v_exp_f32 v39, v39
    v_exp_f32 v40, v40
    v_mfma_f32_32x32x16_bf16 v[16:31], v[196:199], v[180:183], v[16:31]
    s_waitcnt lgkmcnt(2)
    ds_read_b128 v[196:199], v208 offset:13312
    v_exp_f32 v41, v41
    v_exp_f32 v42, v42
    v_exp_f32 v43, v43
    v_smfmac_f32_32x32x32_bf16 v[80:95], v[200:203], v[32:39], v4
    ds_read_b128 v[200:203], v208 offset:18432
    v_exp_f32 v44, v44
    v_exp_f32 v45, v45
    v_exp_f32 v46, v46
    v_smfmac_f32_16x16x64_bf16 v[228:231], v[8:11], v[32:39], v4
    s_waitcnt lgkmcnt(3)
    v_exp_f32 v47, v47
    v_exp_f32 v16, v16
    v_exp_f32 v17, v17
    v_smfmac_f32_32x32x32_bf16 v[80:95], v[204:207], v[40:47], v4
    ds_read_b128 v[204:207], v208 offset:19456
    v_exp_f32 v18, v18
    v_exp_f32 v19, v19
    v_exp_f32 v20, v20
    v_smfmac_f32_16x16x64_bf16 v[228:231], v[8:11], v[40:47], v4
    s_waitcnt lgkmcnt(3)
    s_cmp_eq_u32 s45, 5
    s_cbranch_scc1 L_a_inv4
L_a_val4:
    v_exp_f32 v21, v21
    v_mfma_f32_32x32x16_bf16 v[32:47], v[192:195], v[176:179], v[112:127]
    s_waitcnt lgkmcnt(2)
    ds_read_b128 v[192:195], v208 offset:8192
    v_exp_f32 v22, v22
    v_exp_f32 v23, v23
    v_exp_f32 v24, v24
    v_mfma_f32_32x32x16_bf16 v[32:47], v[196:199], v[180:183], v[32:47]
    s_waitcnt lgkmcnt(2)
    ds_read_b128 v[196:199], v208 offset:9216
    v_exp_f32 v25, v25
    v_exp_f32 v26, v26
    v_exp_f32 v27, v27
    v_smfmac_f32_32x32x32_bf16 v[80:95], v[200:203], v[16:23], v4
    ds_read_b128 v[200:203], v208 offset:14336
    v_exp_f32 v28, v28
    v_exp_f32 v29, v29
    v_exp_f32 v30, v30
    v_smfmac_f32_16x16x64_bf16 v[228:231], v[8:11], v[16:23], v4
    s_waitcnt lgkmcnt(3)
    v_exp_f32 v31, v31
    v_exp_f32 v32, v32
    v_exp_f32 v33, v33
    v_smfmac_f32_32x32x32_bf16 v[80:95], v[204:207], v[24:31], v4
    ds_read_b128 v[204:207], v208 offset:15360
    v_exp_f32 v34, v34
    v_exp_f32 v35, v35
    v_exp_f32 v36, v36
    v_smfmac_f32_16x16x64_bf16 v[228:231], v[8:11], v[24:31], v4
    s_waitcnt lgkmcnt(3)
    s_cmp_eq_u32 s59, 2
    s_cbranch_scc1 L_a_wt5
L_a_wtd5:
    s_cmp_eq_u32 s45, 6
    s_cbranch_scc1 L_a_inv5
L_a_val5:
    v_exp_f32 v37, v37
    v_mfma_f32_32x32x16_bf16 v[16:31], v[192:195], v[176:179], v[112:127]
    s_waitcnt lgkmcnt(2)
    ds_read_b128 v[192:195], v208 offset:4096
    v_exp_f32 v38, v38
    v_exp_f32 v39, v39
    v_exp_f32 v40, v40
    v_mfma_f32_32x32x16_bf16 v[16:31], v[196:199], v[180:183], v[16:31]
    s_waitcnt lgkmcnt(2)
    ds_read_b128 v[196:199], v208 offset:5120
    v_exp_f32 v41, v41
    v_exp_f32 v42, v42
    v_exp_f32 v43, v43
    v_smfmac_f32_32x32x32_bf16 v[80:95], v[200:203], v[32:39], v4
    ds_read_b128 v[200:203], v208 offset:10240
    v_exp_f32 v44, v44
    v_exp_f32 v45, v45
    v_cmp_lt_f32 vcc, s46, v228
    v_exp_f32 v46, v46
    v_smfmac_f32_16x16x64_bf16 v[228:231], v[8:11], v[32:39], v4
    s_waitcnt lgkmcnt(3)
    s_cbranch_vccnz L_resc_a5
L_back_a5:
    v_exp_f32 v47, v47
    v_exp_f32 v16, v16
    v_exp_f32 v17, v17
    v_smfmac_f32_32x32x32_bf16 v[80:95], v[204:207], v[40:47], v4
    ds_read_b128 v[204:207], v208 offset:11264
    v_exp_f32 v18, v18
    v_exp_f32 v19, v19
    v_exp_f32 v20, v20
    v_smfmac_f32_16x16x64_bf16 v[228:231], v[8:11], v[40:47], v4
    s_waitcnt lgkmcnt(3)
    s_cmp_eq_u32 s45, 7
    s_cbranch_scc1 L_a_inv6
L_a_val6:
    v_exp_f32 v21, v21
    v_mfma_f32_32x32x16_bf16 v[32:47], v[192:195], v[176:179], v[112:127]
    s_waitcnt lgkmcnt(2)
    ds_read_b128 v[192:195], v208 offset:0
    v_exp_f32 v22, v22
    v_exp_f32 v23, v23
    v_exp_f32 v24, v24
    v_mfma_f32_32x32x16_bf16 v[32:47], v[196:199], v[180:183], v[32:47]
    s_waitcnt lgkmcnt(2)
    ds_read_b128 v[196:199], v208 offset:1024
    v_exp_f32 v25, v25
    v_exp_f32 v26, v26
    v_exp_f32 v27, v27
    v_smfmac_f32_32x32x32_bf16 v[80:95], v[200:203], v[16:23], v4
    ds_read_b128 v[200:203], v208 offset:6144
    v_exp_f32 v28, v28
    v_exp_f32 v29, v29
    v_exp_f32 v30, v30
    v_smfmac_f32_16x16x64_bf16 v[228:231], v[8:11], v[16:23], v4
    s_waitcnt lgkmcnt(3)
    v_exp_f32 v31, v31
    v_exp_f32 v32, v32
    v_exp_f32 v33, v33
    v_smfmac_f32_32x32x32_bf16 v[80:95], v[204:207], v[24:31], v4
    ds_read_b128 v[204:207], v208 offset:7168
    v_exp_f32 v34, v34
    v_exp_f32 v35, v35
    v_exp_f32 v36, v36
    v_smfmac_f32_16x16x64_bf16 v[228:231], v[8:11], v[24:31], v4
    s_waitcnt lgkmcnt(3)
    s_cmp_eq_u32 s59, 3
    s_cbranch_scc1 L_a_wt7
L_a_wtd7:
    s_cmp_eq_u32 s45, 8
    s_cbranch_scc1 L_a_inv7
L_a_val7:
    v_cndmask_b32 v128, v5, v112, s[64:65]
    v_cndmask_b32 v129, v5, v113, s[66:67]
    v_cndmask_b32 v130, v5, v114, s[68:69]
    v_cndmask_b32 v131, v5, v115, s[70:71]
    v_cndmask_b32 v132, v5, v116, s[72:73]
    v_cndmask_b32 v133, v5, v117, s[74:75]
    v_cndmask_b32 v134, v5, v118, s[76:77]
    v_cndmask_b32 v135, v5, v119, s[78:79]
    v_cndmask_b32 v136, v5, v120, s[80:81]
    v_cndmask_b32 v137, v5, v121, s[82:83]
    v_cndmask_b32 v138, v5, v122, s[84:85]
    v_cndmask_b32 v139, v5, v123, s[86:87]
    v_cndmask_b32 v140, v5, v124, s[88:89]
    v_cndmask_b32 v141, v5, v125, s[90:91]
    v_cndmask_b32 v142, v5, v126, s[92:93]
    v_cndmask_b32 v143, v5, v127, s[94:95]
    s_nop 0
    v_exp_f32 v37, v37
    v_mfma_f32_32x32x16_bf16 v[16:31], v[192:195], v[176:179], v[128:143]
    s_waitcnt lgkmcnt(2)
    ds_read_b128 v[192:195], v208 offset:0
    v_exp_f32 v38, v38
    v_exp_f32 v39, v39
    v_exp_f32 v40, v40
    v_mfma_f32_32x32x16_bf16 v[16:31], v[196:199], v[180:183], v[16:31]
    s_waitcnt lgkmcnt(2)
    ds_read_b128 v[196:199], v208 offset:1024
    v_exp_f32 v41, v41
    v_exp_f32 v42, v42
    v_exp_f32 v43, v43
    v_smfmac_f32_32x32x32_bf16 v[80:95], v[200:203], v[32:39], v4
    ds_read_b128 v[200:203], v208 offset:2048
    v_exp_f32 v44, v44
    v_exp_f32 v45, v45
    v_exp_f32 v46, v46
    v_smfmac_f32_16x16x64_bf16 v[228:231], v[8:11], v[32:39], v4
    s_waitcnt lgkmcnt(3)
    v_exp_f32 v47, v47
    v_exp_f32 v16, v16
    v_exp_f32 v17, v17
    v_smfmac_f32_32x32x32_bf16 v[80:95], v[204:207], v[40:47], v4
    ds_read_b128 v[204:207], v208 offset:3072
    v_exp_f32 v18, v18
    v_exp_f32 v19, v19
    v_exp_f32 v20, v20
    v_smfmac_f32_16x16x64_bf16 v[228:231], v[8:11], v[40:47], v4
    s_waitcnt lgkmcnt(3)
    v_exp_f32 v21, v21
    s_waitcnt lgkmcnt(2)
    ds_read_b128 v[192:195], v208 offset:0
    v_exp_f32 v22, v22
    v_exp_f32 v23, v23
    v_exp_f32 v24, v24
    s_waitcnt lgkmcnt(2)
    ds_read_b128 v[196:199], v208 offset:1024
    v_exp_f32 v25, v25
    v_exp_f32 v26, v26
    v_exp_f32 v27, v27
    v_smfmac_f32_32x32x32_bf16 v[80:95], v[200:203], v[16:23], v4
    ds_read_b128 v[200:203], v208 offset:2048
    v_exp_f32 v28, v28
    v_exp_f32 v29, v29
    v_exp_f32 v30, v30
    v_smfmac_f32_16x16x64_bf16 v[228:231], v[8:11], v[16:23], v4
    s_waitcnt lgkmcnt(3)
    v_exp_f32 v31, v31
    s_waitcnt lgkmcnt(0)
    s_nop 1
    v_smfmac_f32_32x32x32_bf16 v[80:95], v[204:207], v[24:31], v4
    v_smfmac_f32_16x16x64_bf16 v[228:231], v[8:11], v[24:31], v4
    s_nop 12
    v_mul_f32 v2, 0, v228
    v_fma_f32 v2, v80, 0, v2
    v_fma_f32 v2, v81, 0, v2
    v_fma_f32 v2, v82, 0, v2
    v_fma_f32 v2, v83, 0, v2
    v_fma_f32 v2, v84, 0, v2
    v_fma_f32 v2, v85, 0, v2
    v_fma_f32 v2, v86, 0, v2
    v_fma_f32 v2, v87, 0, v2
    v_fma_f32 v2, v88, 0, v2
    v_fma_f32 v2, v89, 0, v2
    v_fma_f32 v2, v90, 0, v2
    v_fma_f32 v2, v91, 0, v2
    v_fma_f32 v2, v92, 0, v2
    v_fma_f32 v2, v93, 0, v2
    v_fma_f32 v2, v94, 0, v2
    v_fma_f32 v2, v95, 0, v2
    v_rcp_f32 v3, v228
    v_cmp_u_f32 vcc, v2, v2
    s_nop 1
    s_cbranch_vccz L_ok_a
    s_min_u32 s55, s45, 9
    s_sub_u32 s54, s55, 1
    s_lshl_b32 s54, s54, 12
    s_sub_u32 s54, s42, s54
    s_cmp_eq_u32 s55, 9
    s_cselect_b32 s57, 1, 2
    s_call_b64 s[52:53], L_slow
    v_rcp_f32 v3, v228
    s_nop 0
L_ok_a:
    v_mul_f32 v80, v3, v80
    v_mul_f32 v81, v3, v81
    v_mul_f32 v82, v3, v82
    v_mul_f32 v83, v3, v83
    v_mul_f32 v84, v3, v84
    v_mul_f32 v85, v3, v85
    v_mul_f32 v86, v3, v86
    v_mul_f32 v87, v3, v87
    v_mul_f32 v88, v3, v88
    v_mul_f32 v89, v3, v89
    v_mul_f32 v90, v3, v90
    v_mul_f32 v91, v3, v91
    v_mul_f32 v92, v3, v92
    v_mul_f32 v93, v3, v93
    v_mul_f32 v94, v3, v94
    v_mul_f32 v95, v3, v95
    v_cvt_pk_bf16_f32 v48, v80, v81
    v_cvt_pk_bf16_f32 v49, v82, v83
    v_cvt_pk_bf16_f32 v50, v84, v85
    v_cvt_pk_bf16_f32 v51, v86, v87
    v_cvt_pk_bf16_f32 v52, v88, v89
    v_cvt_pk_bf16_f32 v53, v90, v91
    v_cvt_pk_bf16_f32 v54, v92, v93
    v_cvt_pk_bf16_f32 v55, v94, v95
    buffer_store_dwordx4 v[48:51], v1, s[12:15], s41 offen sc1
    buffer_store_dwordx4 v[52:55], v1, s[12:15], s41 offen offset:1024 sc1
    v_mov_b32 v176, v168
    v_mov_b32 v177, v169
    v_mov_b32 v178, v170
    v_mov_b32 v179, v171
    v_mov_b32 v180, v172
    v_mov_b32 v181, v173
    v_mov_b32 v182, v174
    v_mov_b32 v183, v175
    s_mov_b32 s4, s22
    s_mov_b32 s5, s23
    s_add_u32 s39, s39, 4096
    s_add_u32 s42, s42, 4096
    s_add_u32 s41, s41, 65536
    s_add_u32 s58, s58, 1
    s_add_u32 s43, s43, 1
    s_cmp_lt_u32 s43, 2
    s_cbranch_scc1 L_ya_unit
    s_load_dwordx2 s[24:25], s[0:1], 48
    v_lshrrev_b32 v16, 5, v0
    v_bfe_u32 v17, v0, 2, 2
    v_lshl_add_u32 v18, v16, 2, v17
    v_lshlrev_b32 v18, 7, v18
    v_and_b32 v19, 1, v0
    v_lshlrev_b32 v19, 2, v19
    v_bfe_u32 v16, v0, 4, 1
    v_or_b32 v19, v19, v16
    v_and_b32 v16, 2, v17
    v_xor_b32 v19, v19, v16
    v_bfe_u32 v16, v0, 1, 1
    v_lshl_add_u32 v18, v16, 3, v18
    v_lshl_add_u32 v12, v19, 4, v18
    v_xor_b32 v13, 32, v12
    v_add_u32 v14, 0x10000, v12
    v_add_u32 v15, 0x10000, v13
    v_lshrrev_b32 v16, 3, v0
    v_and_b32 v17, 7, v0
    v_bfe_u32 v18, v0, 4, 1
    v_lshlrev_b32 v18, 1, v18
    v_xor_b32 v18, v17, v18
    s_lshl_b32 s50, s59, 4
    v_add_u32 v19, s50, v16
    v_lshlrev_b32 v19, 11, v19
    v_lshl_add_u32 v10, v18, 4, v19
    s_lshl_b32 s50, s31, 7
    v_add_u32 v10, s50, v10
    v_add_u32 v9, 15360, v10
    v_xor_b32 v17, v16, v17
    s_lshl_b32 s50, s30, 7
    s_lshl_b32 s51, s59, 5
    s_add_u32 s50, s50, s51
    v_add_u32 v16, s50, v16
    v_lshlrev_b32 v16, 12, v16
    v_lshl_add_u32 v11, v17, 4, v16
    s_lshl_b32 s58, s31, 7
    s_and_b32 s38, s31, 7
    s_lshl_b32 s39, s30, 2
    s_add_u32 s39, s39, s59
    s_lshl_b32 s39, s39, 16
    s_add_u32 s39, s39, 25165824
    s_lshl_b32 s40, s59, 11
    s_mov_b32 s43, 0
    s_mov_b32 s4, s20
    s_mov_b32 s5, s21
    s_mov_b32 s6, 0x200000
    s_mov_b32 s7, 0x00020000
    s_lshl_b32 s49, s33, 1
    s_add_u32 s49, s49, s36
    s_lshl_b32 s49, s49, 12
    s_add_u32 s49, s49, 262144
    s_lshl_b32 s32, s34, 1
    s_add_u32 s32, s32, s37
    s_lshl_b32 s32, s32, 7
    s_add_u32 s32, s32, s49
    s_waitcnt vmcnt(0) lgkmcnt(0)
    s_mov_b32 s8, s24
    s_mov_b32 s9, s25
    s_mov_b32 s10, 0x800000
    s_mov_b32 s11, 0x00020000
    v_lshrrev_b32 v6, 1, v1
    v_mov_b32 v2, s62
    v_mov_b32 v3, s63
    s_mov_b64 exec, 0xffff
    buffer_store_dwordx2 v[2:3], v6, s[12:15], s32 offen sc1
    s_mov_b64 exec, -1
    s_lshl_b32 s49, s30, 1
    s_add_u32 s49, s49, s36
    s_lshl_b32 s49, s49, 12
    s_add_u32 s49, s49, 262144
    s_mov_b32 s52, s22
    s_mov_b32 s53, s23
    s_mov_b32 s54, 0x200000
    s_mov_b32 s55, 0x00020000
    s_mov_b32 s60, 0x98654210
    s_mov_b32 s61, 0xb3f7edca
    s_cmp_eq_u32 s38, 1
    s_cselect_b32 s60, 0xa9865421, s60
    s_cselect_b32 s61, 0x3b7f0edc, s61
    s_cmp_eq_u32 s38, 2
    s_cselect_b32 s60, 0xdca98654, s60
    s_cselect_b32 s61, 0xb3f7210e, s61
    s_cmp_eq_u32 s38, 3
    s_cselect_b32 s60, 0xedca9865, s60
    s_cselect_b32 s61, 0x3b7f4210, s61
    s_cmp_eq_u32 s38, 4
    s_cselect_b32 s60, 0x10edca98, s60
    s_cselect_b32 s61, 0xb3f76542, s61
    s_cmp_eq_u32 s38, 5
    s_cselect_b32 s60, 0x210edca9, s60
    s_cselect_b32 s61, 0x3b7f8654, s61
    s_cmp_eq_u32 s38, 6
    s_cselect_b32 s60, 0x54210edc, s60
    s_cselect_b32 s61, 0xb3f7a986, s61
    s_cmp_eq_u32 s38, 7
    s_cselect_b32 s60, 0x654210ed, s60
    s_cselect_b32 s61, 0x3b7fca98, s61
    s_lshl_b32 s50, s59, 12
    s_add_u32 s50, s50, 106496
    v_and_b32 v16, 31, v0
    v_lshrrev_b32 v17, 5, v0
    v_lshlrev_b32 v17, 2, v17
    v_and_b32 v18, 7, v0
    v_xor_b32 v17, v17, v18
    v_lshlrev_b32 v16, 7, v16
    v_add_u32 v16, s50, v16
    v_lshl_add_u32 v16, v17, 4, v16
    v_xor_b32 v17, 16, v16
    v_xor_b32 v18, 32, v16
    v_xor_b32 v19, 48, v16
    v_add_u32 v20, s50, v1
    v_subrev_u32 v21, 512, v254
    ds_add_u32 v254, v255
    s_add_u32 s48, s48, 4
    s_mov_b32 s100, 4194304
L_spin_p0:
    ds_read_b32 v6, v254
    s_waitcnt lgkmcnt(0)
    v_cmp_le_u32 vcc, s48, v6
    s_cbranch_vccnz L_spind_p0
    s_sleep 2
    s_sub_u32 s100, s100, 1
    s_cbranch_scc0 L_spin_p0
L_spind_p0:
    s_setprio 0
    s_bfe_u32 s44, s60, 0x40000
    s_add_u32 m0, s40, 0
    s_lshl_b32 s44, s44, 17
    buffer_load_dwordx4 v10, s[4:7], s44 offen lds
    buffer_load_dwordx4 v9, s[4:7], s44 offen offset:1024 lds
    s_bfe_u32 s44, s60, 0x40004
    s_add_u32 m0, s40, 8192
    s_lshl_b32 s44, s44, 17
    buffer_load_dwordx4 v10, s[4:7], s44 offen lds
    buffer_load_dwordx4 v9, s[4:7], s44 offen offset:1024 lds
    s_bfe_u32 s44, s60, 0x40008
    s_add_u32 m0, s40, 16384
    s_lshl_b32 s44, s44, 17
    buffer_load_dwordx4 v10, s[4:7], s44 offen lds
    buffer_load_dwordx4 v9, s[4:7], s44 offen offset:1024 lds
    s_bfe_u32 s44, s60, 0x4000c
    s_add_u32 m0, s40, 24576
    s_lshl_b32 s44, s44, 17
    buffer_load_dwordx4 v10, s[4:7], s44 offen lds
    buffer_load_dwordx4 v9, s[4:7], s44 offen offset:1024 lds
    s_bfe_u32 s44, s60, 0x40010
    s_add_u32 m0, s40, 32768
    s_lshl_b32 s44, s44, 17
    buffer_load_dwordx4 v10, s[4:7], s44 offen lds
    buffer_load_dwordx4 v9, s[4:7], s44 offen offset:1024 lds
    s_bfe_u32 s44, s60, 0x40014
    s_add_u32 m0, s40, 40960
    s_lshl_b32 s44, s44, 17
    buffer_load_dwordx4 v10, s[4:7], s44 offen lds
    buffer_load_dwordx4 v9, s[4:7], s44 offen offset:1024 lds
    s_bfe_u32 s44, s60, 0x40018
    s_add_u32 m0, s40, 49152
    s_lshl_b32 s44, s44, 17
    buffer_load_dwordx4 v10, s[4:7], s44 offen lds
    buffer_load_dwordx4 v9, s[4:7], s44 offen offset:1024 lds
    s_bfe_u32 s44, s60, 0x4001c
    s_add_u32 m0, s40, 57344
    s_lshl_b32 s44, s44, 17
    buffer_load_dwordx4 v10, s[4:7], s44 offen lds
    buffer_load_dwordx4 v9, s[4:7], s44 offen offset:1024 lds
    s_mov_b32 s56, 0
    s_bfe_u32 s50, s60, 0x40000
    s_lshl_b32 s51, s50, 1
    s_lshl_b32 s51, 3, s51
    s_and_b32 s101, s56, s51
    s_cmp_eq_u32 s101, s51
    s_cbranch_scc0 L_ypw_0
L_ypwd_0:
    s_lshl_b32 s50, s50, 12
    s_add_u32 s50, s50, s39
    buffer_load_dwordx4 v[96:99], v1, s[12:15], s50 offen offset:0 sc1
    buffer_load_dwordx4 v[100:103], v1, s[12:15], s50 offen offset:1024 sc1
    buffer_load_dwordx4 v[104:107], v1, s[12:15], s50 offen offset:2048 sc1
    buffer_load_dwordx4 v[108:111], v1, s[12:15], s50 offen offset:3072 sc1
    s_bfe_u32 s50, s60, 0x40004
    s_lshl_b32 s51, s50, 1
    s_lshl_b32 s51, 3, s51
    s_and_b32 s101, s56, s51
    s_cmp_eq_u32 s101, s51
    s_cbranch_scc0 L_ypw_1
L_ypwd_1:
    s_lshl_b32 s50, s50, 12
    s_add_u32 s50, s50, s39
    buffer_load_dwordx4 v[112:115], v1, s[12:15], s50 offen offset:0 sc1
    buffer_load_dwordx4 v[116:119], v1, s[12:15], s50 offen offset:1024 sc1
    buffer_load_dwordx4 v[120:123], v1, s[12:15], s50 offen offset:2048 sc1
    buffer_load_dwordx4 v[124:127], v1, s[12:15], s50 offen offset:3072 sc1
    s_bfe_u32 s50, s60, 0x40008
    s_lshl_b32 s51, s50, 1
    s_lshl_b32 s51, 3, s51
    s_and_b32 s101, s56, s51
    s_cmp_eq_u32 s101, s51
    s_cbranch_scc0 L_ypw_2
L_ypwd_2:
    s_lshl_b32 s50, s50, 12
    s_add_u32 s50, s50, s39
    buffer_load_dwordx4 v[128:131], v1, s[12:15], s50 offen offset:0 sc1
    buffer_load_dwordx4 v[132:135], v1, s[12:15], s50 offen offset:1024 sc1
    buffer_load_dwordx4 v[136:139], v1, s[12:15], s50 offen offset:2048 sc1
    buffer_load_dwordx4 v[140:143], v1, s[12:15], s50 offen offset:3072 sc1
    s_setprio 2
    v_mov_b32 v32, 0
    v_mov_b32 v33, 0
    v_mov_b32 v34, 0
    v_mov_b32 v35, 0
    v_mov_b32 v36, 0
    v_mov_b32 v37, 0
    v_mov_b32 v38, 0
    v_mov_b32 v39, 0
    v_mov_b32 v40, 0
    v_mov_b32 v41, 0
    v_mov_b32 v42, 0
    v_mov_b32 v43, 0
    v_mov_b32 v44, 0
    v_mov_b32 v45, 0
    v_mov_b32 v46, 0
    v_mov_b32 v47, 0
    v_mov_b32 v48, 0
    v_mov_b32 v49, 0
    v_mov_b32 v50, 0
    v_mov_b32 v51, 0
    v_mov_b32 v52, 0
    v_mov_b32 v53, 0
    v_mov_b32 v54, 0
    v_mov_b32 v55, 0
    v_mov_b32 v56, 0
    v_mov_b32 v57, 0
    v_mov_b32 v58, 0
    v_mov_b32 v59, 0
    v_mov_b32 v60, 0
    v_mov_b32 v61, 0
    v_mov_b32 v62, 0
    v_mov_b32 v63, 0
    s_waitcnt vmcnt(12)
    ds_add_u32 v254, v255
    s_add_u32 s48, s48, 4
    s_mov_b32 s100, 4194304
L_spin_p10:
    ds_read_b32 v6, v254
    s_waitcnt lgkmcnt(0)
    v_cmp_le_u32 vcc, s48, v6
    s_cbranch_vccnz L_spind_p10
    s_sleep 1
    s_sub_u32 s100, s100, 1
    s_cbranch_scc0 L_spin_p10
L_spind_p10:
    s_setprio 0
    ds_read_b64_tr_b16 v[64:65], v12 offset:0
    ds_read_b64_tr_b16 v[66:67], v12 offset:1024
    ds_read_b64_tr_b16 v[68:69], v13 offset:0
    ds_read_b64_tr_b16 v[70:71], v13 offset:1024
    ds_read_b64_tr_b16 v[72:73], v12 offset:2048
    ds_read_b64_tr_b16 v[74:75], v12 offset:3072
    ds_read_b64_tr_b16 v[76:77], v13 offset:2048
    ds_read_b64_tr_b16 v[78:79], v13 offset:3072
    s_waitcnt vmcnt(8)
    s_bfe_u32 s50, s60, 0x4000c
    s_lshl_b32 s51, s50, 1
    s_lshl_b32 s51, 3, s51
    s_and_b32 s101, s56, s51
    s_cmp_eq_u32 s101, s51
    s_cbranch_scc0 L_ypw_3
L_ypwd_3:
    s_lshl_b32 s50, s50, 12
    s_add_u32 s50, s50, s39
    s_waitcnt lgkmcnt(4)
    v_mfma_f32_32x32x16_bf16 v[32:47], v[64:67], v[96:99], v[32:47]
    ds_read_b64_tr_b16 v[80:81], v12 offset:4096
    ds_read_b64_tr_b16 v[82:83], v12 offset:5120
    buffer_load_dwordx4 v[144:147], v1, s[12:15], s50 offen offset:0 sc1
    v_mfma_f32_32x32x16_bf16 v[48:63], v[68:71], v[96:99], v[48:63]
    ds_read_b64_tr_b16 v[84:85], v13 offset:4096
    ds_read_b64_tr_b16 v[86:87], v13 offset:5120
    s_waitcnt lgkmcnt(4)
    v_mfma_f32_32x32x16_bf16 v[32:47], v[72:75], v[100:103], v[32:47]
    ds_read_b64_tr_b16 v[88:89], v12 offset:6144
    ds_read_b64_tr_b16 v[90:91], v12 offset:7168
    buffer_load_dwordx4 v[148:151], v1, s[12:15], s50 offen offset:1024 sc1
    v_mfma_f32_32x32x16_bf16 v[48:63], v[76:79], v[100:103], v[48:63]
    ds_read_b64_tr_b16 v[92:93], v13 offset:6144
    ds_read_b64_tr_b16 v[94:95], v13 offset:7168
    s_bfe_u32 s44, s61, 0x40000
    s_add_u32 m0, s40, 65536
    s_lshl_b32 s44, s44, 17
    buffer_load_dwordx4 v10, s[4:7], s44 offen lds
    buffer_load_dwordx4 v9, s[4:7], s44 offen offset:1024 lds
    s_waitcnt lgkmcnt(4)
    v_mfma_f32_32x32x16_bf16 v[32:47], v[80:83], v[104:107], v[32:47]
    ds_read_b64_tr_b16 v[64:65], v12 offset:8192
    ds_read_b64_tr_b16 v[66:67], v12 offset:9216
    buffer_load_dwordx4 v[152:155], v1, s[12:15], s50 offen offset:2048 sc1
    v_mfma_f32_32x32x16_bf16 v[48:63], v[84:87], v[104:107], v[48:63]
    ds_read_b64_tr_b16 v[68:69], v13 offset:8192
    ds_read_b64_tr_b16 v[70:71], v13 offset:9216
    s_waitcnt lgkmcnt(4)
    v_mfma_f32_32x32x16_bf16 v[32:47], v[88:91], v[108:111], v[32:47]
    ds_read_b64_tr_b16 v[72:73], v12 offset:10240
    ds_read_b64_tr_b16 v[74:75], v12 offset:11264
    buffer_load_dwordx4 v[156:159], v1, s[12:15], s50 offen offset:3072 sc1
    v_mfma_f32_32x32x16_bf16 v[48:63], v[92:95], v[108:111], v[48:63]
    ds_read_b64_tr_b16 v[76:77], v13 offset:10240
    ds_read_b64_tr_b16 v[78:79], v13 offset:11264
    s_bfe_u32 s44, s61, 0x40004
    s_add_u32 m0, s40, 73728
    s_lshl_b32 s44, s44, 17
    buffer_load_dwordx4 v10, s[4:7], s44 offen lds
    buffer_load_dwordx4 v9, s[4:7], s44 offen offset:1024 lds
    s_waitcnt vmcnt(12)
    s_bfe_u32 s50, s60, 0x40010
    s_lshl_b32 s51, s50, 1
    s_lshl_b32 s51, 3, s51
    s_and_b32 s101, s56, s51
    s_cmp_eq_u32 s101, s51
    s_cbranch_scc0 L_ypw_4
L_ypwd_4:
    s_lshl_b32 s50, s50, 12
    s_add_u32 s50, s50, s39
    s_waitcnt lgkmcnt(4)
    ds_add_u32 v254, v255
    s_add_u32 s48, s48, 4
    v_mfma_f32_32x32x16_bf16 v[32:47], v[64:67], v[112:115], v[32:47]
    ds_read_b64_tr_b16 v[80:81], v12 offset:12288
    ds_read_b64_tr_b16 v[82:83], v12 offset:13312
    buffer_load_dwordx4 v[160:163], v1, s[12:15], s50 offen offset:0 sc1
    v_mfma_f32_32x32x16_bf16 v[48:63], v[68:71], v[112:115], v[48:63]
    ds_read_b64_tr_b16 v[84:85], v13 offset:12288
    ds_read_b64_tr_b16 v[86:87], v13 offset:13312
    s_waitcnt lgkmcnt(5)
    v_mfma_f32_32x32x16_bf16 v[32:47], v[72:75], v[116:119], v[32:47]
    ds_read_b64_tr_b16 v[88:89], v12 offset:14336
    ds_read_b64_tr_b16 v[90:91], v12 offset:15360
    buffer_load_dwordx4 v[164:167], v1, s[12:15], s50 offen offset:1024 sc1
    v_mfma_f32_32x32x16_bf16 v[48:63], v[76:79], v[116:119], v[48:63]
    ds_read_b64_tr_b16 v[92:93], v13 offset:14336
    ds_read_b64_tr_b16 v[94:95], v13 offset:15360
    s_bfe_u32 s44, s61, 0x40008
    s_add_u32 m0, s40, 81920
    s_lshl_b32 s44, s44, 17
    buffer_load_dwordx4 v10, s[4:7], s44 offen lds
    buffer_load_dwordx4 v9, s[4:7], s44 offen offset:1024 lds
    s_waitcnt lgkmcnt(4)
    v_mfma_f32_32x32x16_bf16 v[32:47], v[80:83], v[120:123], v[32:47]
    ds_read_b64_tr_b16 v[64:65], v12 offset:16384
    ds_read_b64_tr_b16 v[66:67], v12 offset:17408
    buffer_load_dwordx4 v[168:171], v1, s[12:15], s50 offen offset:2048 sc1
    v_mfma_f32_32x32x16_bf16 v[48:63], v[84:87], v[120:123], v[48:63]
    ds_read_b64_tr_b16 v[68:69], v13 offset:16384
    ds_read_b64_tr_b16 v[70:71], v13 offset:17408
    s_waitcnt lgkmcnt(4)
    v_mfma_f32_32x32x16_bf16 v[32:47], v[88:91], v[124:127], v[32:47]
    ds_read_b64_tr_b16 v[72:73], v12 offset:18432
    ds_read_b64_tr_b16 v[74:75], v12 offset:19456
    buffer_load_dwordx4 v[172:175], v1, s[12:15], s50 offen offset:3072 sc1
    v_mfma_f32_32x32x16_bf16 v[48:63], v[92:95], v[124:127], v[48:63]
    ds_read_b64_tr_b16 v[76:77], v13 offset:18432
    ds_read_b64_tr_b16 v[78:79], v13 offset:19456
    s_bfe_u32 s44, s61, 0x4000c
    s_add_u32 m0, s40, 90112
    s_lshl_b32 s44, s44, 17
    buffer_load_dwordx4 v10, s[4:7], s44 offen lds
    buffer_load_dwordx4 v9, s[4:7], s44 offen offset:1024 lds
    s_waitcnt vmcnt(16)
    s_bfe_u32 s50, s60, 0x40014
    s_lshl_b32 s51, s50, 1
    s_lshl_b32 s51, 3, s51
    s_and_b32 s101, s56, s51
    s_cmp_eq_u32 s101, s51
    s_cbranch_scc0 L_ypw_5
L_ypwd_5:
    s_lshl_b32 s50, s50, 12
    s_add_u32 s50, s50, s39
    s_waitcnt lgkmcnt(4)
    v_mfma_f32_32x32x16_bf16 v[32:47], v[64:67], v[128:131], v[32:47]
    ds_read_b64_tr_b16 v[80:81], v12 offset:20480
    ds_read_b64_tr_b16 v[82:83], v12 offset:21504
    buffer_load_dwordx4 v[176:179], v1, s[12:15], s50 offen offset:0 sc1
    v_mfma_f32_32x32x16_bf16 v[48:63], v[68:71], v[128:131], v[48:63]
    ds_read_b64_tr_b16 v[84:85], v13 offset:20480
    ds_read_b64_tr_b16 v[86:87], v13 offset:21504
    s_waitcnt lgkmcnt(4)
    v_mfma_f32_32x32x16_bf16 v[32:47], v[72:75], v[132:135], v[32:47]
    ds_read_b64_tr_b16 v[88:89], v12 offset:22528
    ds_read_b64_tr_b16 v[90:91], v12 offset:23552
    buffer_load_dwordx4 v[180:183], v1, s[12:15], s50 offen offset:1024 sc1
    v_mfma_f32_32x32x16_bf16 v[48:63], v[76:79], v[132:135], v[48:63]
    ds_read_b64_tr_b16 v[92:93], v13 offset:22528
    ds_read_b64_tr_b16 v[94:95], v13 offset:23552
    ds_read_b32 v6, v254
    s_bfe_u32 s44, s61, 0x40010
    s_add_u32 m0, s40, 98304
    s_lshl_b32 s44, s44, 17
    buffer_load_dwordx4 v10, s[4:7], s44 offen lds
    buffer_load_dwordx4 v9, s[4:7], s44 offen offset:1024 lds
    s_waitcnt lgkmcnt(5)
    v_mfma_f32_32x32x16_bf16 v[32:47], v[80:83], v[136:139], v[32:47]
    ds_read_b64_tr_b16 v[64:65], v12 offset:24576
    ds_read_b64_tr_b16 v[66:67], v12 offset:25600
    buffer_load_dwordx4 v[184:187], v1, s[12:15], s50 offen offset:2048 sc1
    v_mfma_f32_32x32x16_bf16 v[48:63], v[84:87], v[136:139], v[48:63]
    ds_read_b64_tr_b16 v[68:69], v13 offset:24576
    ds_read_b64_tr_b16 v[70:71], v13 offset:25600
    s_waitcnt lgkmcnt(5)
    v_mfma_f32_32x32x16_bf16 v[32:47], v[88:91], v[140:143], v[32:47]
    ds_read_b64_tr_b16 v[72:73], v12 offset:26624
    ds_read_b64_tr_b16 v[74:75], v12 offset:27648
    buffer_load_dwordx4 v[188:191], v1, s[12:15], s50 offen offset:3072 sc1
    v_mfma_f32_32x32x16_bf16 v[48:63], v[92:95], v[140:143], v[48:63]
    ds_read_b64_tr_b16 v[76:77], v13 offset:26624
    ds_read_b64_tr_b16 v[78:79], v13 offset:27648
    s_waitcnt vmcnt(16)
    s_bfe_u32 s50, s60, 0x40018
    s_lshl_b32 s51, s50, 1
    s_lshl_b32 s51, 3, s51
    s_and_b32 s101, s56, s51
    s_cmp_eq_u32 s101, s51
    s_cbranch_scc0 L_ypw_6
L_ypwd_6:
    s_lshl_b32 s50, s50, 12
    s_add_u32 s50, s50, s39
    s_waitcnt lgkmcnt(4)
    v_cmp_gt_u32 vcc, s48, v6
    s_cbranch_vccnz L_yps_3
L_ypsd_3:
    ds_add_u32 v254, v255
    s_add_u32 s48, s48, 4
    v_mfma_f32_32x32x16_bf16 v[32:47], v[64:67], v[144:147], v[32:47]
    ds_read_b64_tr_b16 v[80:81], v12 offset:28672
    ds_read_b64_tr_b16 v[82:83], v12 offset:29696
    buffer_load_dwordx4 v[192:195], v1, s[12:15], s50 offen offset:0 sc1
    v_mfma_f32_32x32x16_bf16 v[48:63], v[68:71], v[144:147], v[48:63]
    ds_read_b64_tr_b16 v[84:85], v13 offset:28672
    ds_read_b64_tr_b16 v[86:87], v13 offset:29696
    s_waitcnt lgkmcnt(5)
    v_mfma_f32_32x32x16_bf16 v[32:47], v[72:75], v[148:151], v[32:47]
    ds_read_b64_tr_b16 v[88:89], v12 offset:30720
    ds_read_b64_tr_b16 v[90:91], v12 offset:31744
    buffer_load_dwordx4 v[196:199], v1, s[12:15], s50 offen offset:1024 sc1
    v_mfma_f32_32x32x16_bf16 v[48:63], v[76:79], v[148:151], v[48:63]
    ds_read_b64_tr_b16 v[92:93], v13 offset:30720
    ds_read_b64_tr_b16 v[94:95], v13 offset:31744
    s_bfe_u32 s44, s61, 0x40014
    s_add_u32 m0, s40, 0
    s_lshl_b32 s44, s44, 17
    buffer_load_dwordx4 v10, s[4:7], s44 offen lds
    buffer_load_dwordx4 v9, s[4:7], s44 offen offset:1024 lds
    s_waitcnt lgkmcnt(4)
    v_mfma_f32_32x32x16_bf16 v[32:47], v[80:83], v[152:155], v[32:47]
    ds_read_b64_tr_b16 v[64:65], v12 offset:32768
    ds_read_b64_tr_b16 v[66:67], v12 offset:33792
    buffer_load_dwordx4 v[200:203], v1, s[12:15], s50 offen offset:2048 sc1
    v_mfma_f32_32x32x16_bf16 v[48:63], v[84:87], v[152:155], v[48:63]
    ds_read_b64_tr_b16 v[68:69], v13 offset:32768
    ds_read_b64_tr_b16 v[70:71], v13 offset:33792
    s_waitcnt lgkmcnt(4)
    v_mfma_f32_32x32x16_bf16 v[32:47], v[88:91], v[156:159], v[32:47]
    ds_read_b64_tr_b16 v[72:73], v12 offset:34816
    ds_read_b64_tr_b16 v[74:75], v12 offset:35840
    buffer_load_dwordx4 v[204:207], v1, s[12:15], s50 offen offset:3072 sc1
    v_mfma_f32_32x32x16_bf16 v[48:63], v[92:95], v[156:159], v[48:63]
    ds_read_b64_tr_b16 v[76:77], v13 offset:34816
    ds_read_b64_tr_b16 v[78:79], v13 offset:35840
    s_waitcnt vmcnt(14)
    s_bfe_u32 s50, s60, 0x4001c
    s_lshl_b32 s51, s50, 1
    s_lshl_b32 s51, 3, s51
    s_and_b32 s101, s56, s51
    s_cmp_eq_u32 s101, s51
    s_cbranch_scc0 L_ypw_7
L_ypwd_7:
    s_lshl_b32 s50, s50, 12
    s_add_u32 s50, s50, s39
    s_waitcnt lgkmcnt(4)
    v_mfma_f32_32x32x16_bf16 v[32:47], v[64:67], v[160:163], v[32:47]
    ds_read_b64_tr_b16 v[80:81], v12 offset:36864
    ds_read_b64_tr_b16 v[82:83], v12 offset:37888
    buffer_load_dwordx4 v[208:211], v1, s[12:15], s50 offen offset:0 sc1
    v_mfma_f32_32x32x16_bf16 v[48:63], v[68:71], v[160:163], v[48:63]
    ds_read_b64_tr_b16 v[84:85], v13 offset:36864
    ds_read_b64_tr_b16 v[86:87], v13 offset:37888
    s_waitcnt lgkmcnt(4)
    v_mfma_f32_32x32x16_bf16 v[32:47], v[72:75], v[164:167], v[32:47]
    ds_read_b64_tr_b16 v[88:89], v12 offset:38912
    ds_read_b64_tr_b16 v[90:91], v12 offset:39936
    buffer_load_dwordx4 v[212:215], v1, s[12:15], s50 offen offset:1024 sc1
    v_mfma_f32_32x32x16_bf16 v[48:63], v[76:79], v[164:167], v[48:63]
    ds_read_b64_tr_b16 v[92:93], v13 offset:38912
    ds_read_b64_tr_b16 v[94:95], v13 offset:39936
    ds_read_b32 v6, v254
    s_waitcnt lgkmcnt(5)
    v_mfma_f32_32x32x16_bf16 v[32:47], v[80:83], v[168:171], v[32:47]
    ds_read_b64_tr_b16 v[64:65], v12 offset:40960
    ds_read_b64_tr_b16 v[66:67], v12 offset:41984
    buffer_load_dwordx4 v[216:219], v1, s[12:15], s50 offen offset:2048 sc1
    v_mfma_f32_32x32x16_bf16 v[48:63], v[84:87], v[168:171], v[48:63]
    ds_read_b64_tr_b16 v[68:69], v13 offset:40960
    ds_read_b64_tr_b16 v[70:71], v13 offset:41984
    s_waitcnt lgkmcnt(5)
    v_mfma_f32_32x32x16_bf16 v[32:47], v[88:91], v[172:175], v[32:47]
    ds_read_b64_tr_b16 v[72:73], v12 offset:43008
    ds_read_b64_tr_b16 v[74:75], v12 offset:44032
    buffer_load_dwordx4 v[220:223], v1, s[12:15], s50 offen offset:3072 sc1
    v_mfma_f32_32x32x16_bf16 v[48:63], v[92:95], v[172:175], v[48:63]
    ds_read_b64_tr_b16 v[76:77], v13 offset:43008
    ds_read_b64_tr_b16 v[78:79], v13 offset:44032
    s_waitcnt vmcnt(10)
    s_bfe_u32 s50, s61, 0x40000
    s_lshl_b32 s51, s50, 1
    s_lshl_b32 s51, 3, s51
    s_and_b32 s101, s56, s51
    s_cmp_eq_u32 s101, s51
    s_cbranch_scc0 L_ypw_8
L_ypwd_8:
    s_lshl_b32 s50, s50, 12
    s_add_u32 s50, s50, s39
    s_waitcnt lgkmcnt(4)
    v_cmp_gt_u32 vcc, s48, v6
    s_cbranch_vccnz L_yps_5
L_ypsd_5:
    ds_add_u32 v254, v255
    s_add_u32 s48, s48, 4
    v_mfma_f32_32x32x16_bf16 v[32:47], v[64:67], v[176:179], v[32:47]
    ds_read_b64_tr_b16 v[80:81], v12 offset:45056
    ds_read_b64_tr_b16 v[82:83], v12 offset:46080
    buffer_load_dwordx4 v[96:99], v1, s[12:15], s50 offen offset:0 sc1
    v_mfma_f32_32x32x16_bf16 v[48:63], v[68:71], v[176:179], v[48:63]
    ds_read_b64_tr_b16 v[84:85], v13 offset:45056
    ds_read_b64_tr_b16 v[86:87], v13 offset:46080
    s_waitcnt lgkmcnt(5)
    v_mfma_f32_32x32x16_bf16 v[32:47], v[72:75], v[180:183], v[32:47]
    ds_read_b64_tr_b16 v[88:89], v12 offset:47104
    ds_read_b64_tr_b16 v[90:91], v12 offset:48128
    buffer_load_dwordx4 v[100:103], v1, s[12:15], s50 offen offset:1024 sc1
    v_mfma_f32_32x32x16_bf16 v[48:63], v[76:79], v[180:183], v[48:63]
    ds_read_b64_tr_b16 v[92:93], v13 offset:47104
    ds_read_b64_tr_b16 v[94:95], v13 offset:48128
    s_bfe_u32 s44, s61, 0x40018
    s_add_u32 m0, s40, 8192
    s_lshl_b32 s44, s44, 17
    buffer_load_dwordx4 v10, s[4:7], s44 offen lds
    buffer_load_dwordx4 v9, s[4:7], s44 offen offset:1024 lds
    s_waitcnt lgkmcnt(4)
    v_mfma_f32_32x32x16_bf16 v[32:47], v[80:83], v[184:187], v[32:47]
    ds_read_b64_tr_b16 v[64:65], v12 offset:49152
    ds_read_b64_tr_b16 v[66:67], v12 offset:50176
    buffer_load_dwordx4 v[104:107], v1, s[12:15], s50 offen offset:2048 sc1
    v_mfma_f32_32x32x16_bf16 v[48:63], v[84:87], v[184:187], v[48:63]
    ds_read_b64_tr_b16 v[68:69], v13 offset:49152
    ds_read_b64_tr_b16 v[70:71], v13 offset:50176
    s_waitcnt lgkmcnt(4)
    v_mfma_f32_32x32x16_bf16 v[32:47], v[88:91], v[188:191], v[32:47]
    ds_read_b64_tr_b16 v[72:73], v12 offset:51200
    ds_read_b64_tr_b16 v[74:75], v12 offset:52224
    buffer_load_dwordx4 v[108:111], v1, s[12:15], s50 offen offset:3072 sc1
    v_mfma_f32_32x32x16_bf16 v[48:63], v[92:95], v[188:191], v[48:63]
    ds_read_b64_tr_b16 v[76:77], v13 offset:51200
    ds_read_b64_tr_b16 v[78:79], v13 offset:52224
    s_bfe_u32 s44, s61, 0x4001c
    s_add_u32 m0, s40, 16384
    s_lshl_b32 s44, s44, 17
    buffer_load_dwordx4 v10, s[4:7], s44 offen lds
    buffer_load_dwordx4 v9, s[4:7], s44 offen offset:1024 lds
    s_waitcnt vmcnt(12)
    s_bfe_u32 s50, s61, 0x40004
    s_lshl_b32 s51, s50, 1
    s_lshl_b32 s51, 3, s51
    s_and_b32 s101, s56, s51
    s_cmp_eq_u32 s101, s51
    s_cbranch_scc0 L_ypw_9
L_ypwd_9:
    s_lshl_b32 s50, s50, 12
    s_add_u32 s50, s50, s39
    s_waitcnt lgkmcnt(4)
    v_mfma_f32_32x32x16_bf16 v[32:47], v[64:67], v[192:195], v[32:47]
    ds_read_b64_tr_b16 v[80:81], v12 offset:53248
    ds_read_b64_tr_b16 v[82:83], v12 offset:54272
    buffer_load_dwordx4 v[112:115], v1, s[12:15], s50 offen offset:0 sc1
    v_mfma_f32_32x32x16_bf16 v[48:63], v[68:71], v[192:195], v[48:63]
    ds_read_b64_tr_b16 v[84:85], v13 offset:53248
    ds_read_b64_tr_b16 v[86:87], v13 offset:54272
    s_waitcnt lgkmcnt(4)
    v_mfma_f32_32x32x16_bf16 v[32:47], v[72:75], v[196:199], v[32:47]
    ds_read_b64_tr_b16 v[88:89], v12 offset:55296
    ds_read_b64_tr_b16 v[90:91], v12 offset:56320
    buffer_load_dwordx4 v[116:119], v1, s[12:15], s50 offen offset:1024 sc1
    v_mfma_f32_32x32x16_bf16 v[48:63], v[76:79], v[196:199], v[48:63]
    ds_read_b64_tr_b16 v[92:93], v13 offset:55296
    ds_read_b64_tr_b16 v[94:95], v13 offset:56320
    ds_read_b32 v6, v254
    s_waitcnt lgkmcnt(5)
    v_mfma_f32_32x32x16_bf16 v[32:47], v[80:83], v[200:203], v[32:47]
    ds_read_b64_tr_b16 v[64:65], v12 offset:57344
    ds_read_b64_tr_b16 v[66:67], v12 offset:58368
    buffer_load_dwordx4 v[120:123], v1, s[12:15], s50 offen offset:2048 sc1
    v_mfma_f32_32x32x16_bf16 v[48:63], v[84:87], v[200:203], v[48:63]
    ds_read_b64_tr_b16 v[68:69], v13 offset:57344
    ds_read_b64_tr_b16 v[70:71], v13 offset:58368
    s_waitcnt lgkmcnt(5)
    v_mfma_f32_32x32x16_bf16 v[32:47], v[88:91], v[204:207], v[32:47]
    ds_read_b64_tr_b16 v[72:73], v12 offset:59392
    ds_read_b64_tr_b16 v[74:75], v12 offset:60416
    buffer_load_dwordx4 v[124:127], v1, s[12:15], s50 offen offset:3072 sc1
    v_mfma_f32_32x32x16_bf16 v[48:63], v[92:95], v[204:207], v[48:63]
    ds_read_b64_tr_b16 v[76:77], v13 offset:59392
    ds_read_b64_tr_b16 v[78:79], v13 offset:60416
    s_waitcnt vmcnt(12)
    s_bfe_u32 s50, s61, 0x40008
    s_lshl_b32 s51, s50, 1
    s_lshl_b32 s51, 3, s51
    s_and_b32 s101, s56, s51
    s_cmp_eq_u32 s101, s51
    s_cbranch_scc0 L_ypw_10
L_ypwd_10:
    s_lshl_b32 s50, s50, 12
    s_add_u32 s50, s50, s39
    s_waitcnt lgkmcnt(4)
    v_cmp_gt_u32 vcc, s48, v6
    s_cbranch_vccnz L_yps_7
L_ypsd_7:
    ds_add_u32 v254, v255
    s_add_u32 s48, s48, 4
    v_mfma_f32_32x32x16_bf16 v[32:47], v[64:67], v[208:211], v[32:47]
    ds_read_b64_tr_b16 v[80:81], v12 offset:61440
    ds_read_b64_tr_b16 v[82:83], v12 offset:62464
    buffer_load_dwordx4 v[128:131], v1, s[12:15], s50 offen offset:0 sc1
    v_mfma_f32_32x32x16_bf16 v[48:63], v[68:71], v[208:211], v[48:63]
    ds_read_b64_tr_b16 v[84:85], v13 offset:61440
    ds_read_b64_tr_b16 v[86:87], v13 offset:62464
    s_waitcnt lgkmcnt(5)
    v_mfma_f32_32x32x16_bf16 v[32:47], v[72:75], v[212:215], v[32:47]
    ds_read_b64_tr_b16 v[88:89], v12 offset:63488
    ds_read_b64_tr_b16 v[90:91], v12 offset:64512
    buffer_load_dwordx4 v[132:135], v1, s[12:15], s50 offen offset:1024 sc1
    v_mfma_f32_32x32x16_bf16 v[48:63], v[76:79], v[212:215], v[48:63]
    ds_read_b64_tr_b16 v[92:93], v13 offset:63488
    ds_read_b64_tr_b16 v[94:95], v13 offset:64512
    s_bfe_u32 s44, s60, 0x40000
    s_add_u32 m0, s40, 24576
    s_lshl_b32 s44, s44, 17
    buffer_load_dwordx4 v10, s[52:55], s44 offen lds
    buffer_load_dwordx4 v9, s[52:55], s44 offen offset:1024 lds
    s_waitcnt lgkmcnt(4)
    v_mfma_f32_32x32x16_bf16 v[32:47], v[80:83], v[216:219], v[32:47]
    ds_read_b64_tr_b16 v[64:65], v14 offset:0
    ds_read_b64_tr_b16 v[66:67], v14 offset:1024
    buffer_load_dwordx4 v[136:139], v1, s[12:15], s50 offen offset:2048 sc1
    v_mfma_f32_32x32x16_bf16 v[48:63], v[84:87], v[216:219], v[48:63]
    ds_read_b64_tr_b16 v[68:69], v15 offset:0
    ds_read_b64_tr_b16 v[70:71], v15 offset:1024
    s_waitcnt lgkmcnt(4)
    v_mfma_f32_32x32x16_bf16 v[32:47], v[88:91], v[220:223], v[32:47]
    ds_read_b64_tr_b16 v[72:73], v14 offset:2048
    ds_read_b64_tr_b16 v[74:75], v14 offset:3072
    buffer_load_dwordx4 v[140:143], v1, s[12:15], s50 offen offset:3072 sc1
    v_mfma_f32_32x32x16_bf16 v[48:63], v[92:95], v[220:223], v[48:63]
    ds_read_b64_tr_b16 v[76:77], v15 offset:2048
    ds_read_b64_tr_b16 v[78:79], v15 offset:3072
    s_bfe_u32 s44, s60, 0x40004
    s_add_u32 m0, s40, 32768
    s_lshl_b32 s44, s44, 17
    buffer_load_dwordx4 v10, s[52:55], s44 offen lds
    buffer_load_dwordx4 v9, s[52:55], s44 offen offset:1024 lds
    s_waitcnt vmcnt(14)
    s_bfe_u32 s50, s61, 0x4000c
    s_lshl_b32 s51, s50, 1
    s_lshl_b32 s51, 3, s51
    s_and_b32 s101, s56, s51
    s_cmp_eq_u32 s101, s51
    s_cbranch_scc0 L_ypw_11
L_ypwd_11:
    s_lshl_b32 s50, s50, 12
    s_add_u32 s50, s50, s39
    s_waitcnt lgkmcnt(4)
    v_mfma_f32_32x32x16_bf16 v[32:47], v[64:67], v[96:99], v[32:47]
    ds_read_b64_tr_b16 v[80:81], v14 offset:4096
    ds_read_b64_tr_b16 v[82:83], v14 offset:5120
    buffer_load_dwordx4 v[144:147], v1, s[12:15], s50 offen offset:0 sc1
    v_mfma_f32_32x32x16_bf16 v[48:63], v[68:71], v[96:99], v[48:63]
    ds_read_b64_tr_b16 v[84:85], v15 offset:4096
    ds_read_b64_tr_b16 v[86:87], v15 offset:5120
    s_waitcnt lgkmcnt(4)
    v_mfma_f32_32x32x16_bf16 v[32:47], v[72:75], v[100:103], v[32:47]
    ds_read_b64_tr_b16 v[88:89], v14 offset:6144
    ds_read_b64_tr_b16 v[90:91], v14 offset:7168
    buffer_load_dwordx4 v[148:151], v1, s[12:15], s50 offen offset:1024 sc1
    v_mfma_f32_32x32x16_bf16 v[48:63], v[76:79], v[100:103], v[48:63]
    ds_read_b64_tr_b16 v[92:93], v15 offset:6144
    ds_read_b64_tr_b16 v[94:95], v15 offset:7168
    ds_read_b32 v6, v254
    s_waitcnt lgkmcnt(5)
    v_mfma_f32_32x32x16_bf16 v[32:47], v[80:83], v[104:107], v[32:47]
    ds_read_b64_tr_b16 v[64:65], v14 offset:8192
    ds_read_b64_tr_b16 v[66:67], v14 offset:9216
    buffer_load_dwordx4 v[152:155], v1, s[12:15], s50 offen offset:2048 sc1
    v_mfma_f32_32x32x16_bf16 v[48:63], v[84:87], v[104:107], v[48:63]
    ds_read_b64_tr_b16 v[68:69], v15 offset:8192
    ds_read_b64_tr_b16 v[70:71], v15 offset:9216
    s_waitcnt lgkmcnt(5)
    v_mfma_f32_32x32x16_bf16 v[32:47], v[88:91], v[108:111], v[32:47]
    ds_read_b64_tr_b16 v[72:73], v14 offset:10240
    ds_read_b64_tr_b16 v[74:75], v14 offset:11264
    buffer_load_dwordx4 v[156:159], v1, s[12:15], s50 offen offset:3072 sc1
    v_mfma_f32_32x32x16_bf16 v[48:63], v[92:95], v[108:111], v[48:63]
    ds_read_b64_tr_b16 v[76:77], v15 offset:10240
    ds_read_b64_tr_b16 v[78:79], v15 offset:11264
    s_waitcnt vmcnt(12)
    s_bfe_u32 s50, s61, 0x40010
    s_lshl_b32 s51, s50, 1
    s_lshl_b32 s51, 3, s51
    s_and_b32 s101, s56, s51
    s_cmp_eq_u32 s101, s51
    s_cbranch_scc0 L_ypw_12
L_ypwd_12:
    s_lshl_b32 s50, s50, 12
    s_add_u32 s50, s50, s39
    s_waitcnt lgkmcnt(4)
    v_cmp_gt_u32 vcc, s48, v6
    s_cbranch_vccnz L_yps_9
L_ypsd_9:
    ds_add_u32 v254, v255
    s_add_u32 s48, s48, 4
    v_mfma_f32_32x32x16_bf16 v[32:47], v[64:67], v[112:115], v[32:47]
    ds_read_b64_tr_b16 v[80:81], v14 offset:12288
    ds_read_b64_tr_b16 v[82:83], v14 offset:13312
    buffer_load_dwordx4 v[160:163], v1, s[12:15], s50 offen offset:0 sc1
    v_mfma_f32_32x32x16_bf16 v[48:63], v[68:71], v[112:115], v[48:63]
    ds_read_b64_tr_b16 v[84:85], v15 offset:12288
    ds_read_b64_tr_b16 v[86:87], v15 offset:13312
    s_waitcnt lgkmcnt(5)
    v_mfma_f32_32x32x16_bf16 v[32:47], v[72:75], v[116:119], v[32:47]
    ds_read_b64_tr_b16 v[88:89], v14 offset:14336
    ds_read_b64_tr_b16 v[90:91], v14 offset:15360
    buffer_load_dwordx4 v[164:167], v1, s[12:15], s50 offen offset:1024 sc1
    v_mfma_f32_32x32x16_bf16 v[48:63], v[76:79], v[116:119], v[48:63]
    ds_read_b64_tr_b16 v[92:93], v15 offset:14336
    ds_read_b64_tr_b16 v[94:95], v15 offset:15360
    s_bfe_u32 s44, s60, 0x40008
    s_add_u32 m0, s40, 40960
    s_lshl_b32 s44, s44, 17
    buffer_load_dwordx4 v10, s[52:55], s44 offen lds
    buffer_load_dwordx4 v9, s[52:55], s44 offen offset:1024 lds
    s_waitcnt lgkmcnt(4)
    v_mfma_f32_32x32x16_bf16 v[32:47], v[80:83], v[120:123], v[32:47]
    ds_read_b64_tr_b16 v[64:65], v14 offset:16384
    ds_read_b64_tr_b16 v[66:67], v14 offset:17408
    buffer_load_dwordx4 v[168:171], v1, s[12:15], s50 offen offset:2048 sc1
    v_mfma_f32_32x32x16_bf16 v[48:63], v[84:87], v[120:123], v[48:63]
    ds_read_b64_tr_b16 v[68:69], v15 offset:16384
    ds_read_b64_tr_b16 v[70:71], v15 offset:17408
    s_waitcnt lgkmcnt(4)
    v_mfma_f32_32x32x16_bf16 v[32:47], v[88:91], v[124:127], v[32:47]
    ds_read_b64_tr_b16 v[72:73], v14 offset:18432
    ds_read_b64_tr_b16 v[74:75], v14 offset:19456
    buffer_load_dwordx4 v[172:175], v1, s[12:15], s50 offen offset:3072 sc1
    v_mfma_f32_32x32x16_bf16 v[48:63], v[92:95], v[124:127], v[48:63]
    ds_read_b64_tr_b16 v[76:77], v15 offset:18432
    ds_read_b64_tr_b16 v[78:79], v15 offset:19456
    s_bfe_u32 s44, s60, 0x4000c
    s_add_u32 m0, s40, 49152
    s_lshl_b32 s44, s44, 17
    buffer_load_dwordx4 v10, s[52:55], s44 offen lds
    buffer_load_dwordx4 v9, s[52:55], s44 offen offset:1024 lds
    s_waitcnt vmcnt(14)
    s_bfe_u32 s50, s61, 0x40014
    s_lshl_b32 s51, s50, 1
    s_lshl_b32 s51, 3, s51
    s_and_b32 s101, s56, s51
    s_cmp_eq_u32 s101, s51
    s_cbranch_scc0 L_ypw_13
L_ypwd_13:
    s_lshl_b32 s50, s50, 12
    s_add_u32 s50, s50, s39
    s_waitcnt lgkmcnt(4)
    v_mfma_f32_32x32x16_bf16 v[32:47], v[64:67], v[128:131], v[32:47]
    ds_read_b64_tr_b16 v[80:81], v14 offset:20480
    ds_read_b64_tr_b16 v[82:83], v14 offset:21504
    buffer_load_dwordx4 v[176:179], v1, s[12:15], s50 offen offset:0 sc1
    v_mfma_f32_32x32x16_bf16 v[48:63], v[68:71], v[128:131], v[48:63]
    ds_read_b64_tr_b16 v[84:85], v15 offset:20480
    ds_read_b64_tr_b16 v[86:87], v15 offset:21504
    s_waitcnt lgkmcnt(4)
    v_mfma_f32_32x32x16_bf16 v[32:47], v[72:75], v[132:135], v[32:47]
    ds_read_b64_tr_b16 v[88:89], v14 offset:22528
    ds_read_b64_tr_b16 v[90:91], v14 offset:23552
    buffer_load_dwordx4 v[180:183], v1, s[12:15], s50 offen offset:1024 sc1
    v_mfma_f32_32x32x16_bf16 v[48:63], v[76:79], v[132:135], v[48:63]
    ds_read_b64_tr_b16 v[92:93], v15 offset:22528
    ds_read_b64_tr_b16 v[94:95], v15 offset:23552
    ds_read_b32 v6, v254
    s_waitcnt lgkmcnt(5)
    v_mfma_f32_32x32x16_bf16 v[32:47], v[80:83], v[136:139], v[32:47]
    ds_read_b64_tr_b16 v[64:65], v14 offset:24576
    ds_read_b64_tr_b16 v[66:67], v14 offset:25600
    buffer_load_dwordx4 v[184:187], v1, s[12:15], s50 offen offset:2048 sc1
    v_mfma_f32_32x32x16_bf16 v[48:63], v[84:87], v[136:139], v[48:63]
    ds_read_b64_tr_b16 v[68:69], v15 offset:24576
    ds_read_b64_tr_b16 v[70:71], v15 offset:25600
    s_waitcnt lgkmcnt(5)
    v_mfma_f32_32x32x16_bf16 v[32:47], v[88:91], v[140:143], v[32:47]
    ds_read_b64_tr_b16 v[72:73], v14 offset:26624
    ds_read_b64_tr_b16 v[74:75], v14 offset:27648
    buffer_load_dwordx4 v[188:191], v1, s[12:15], s50 offen offset:3072 sc1
    v_mfma_f32_32x32x16_bf16 v[48:63], v[92:95], v[140:143], v[48:63]
    ds_read_b64_tr_b16 v[76:77], v15 offset:26624
    ds_read_b64_tr_b16 v[78:79], v15 offset:27648
    s_waitcnt vmcnt(12)
    s_bfe_u32 s50, s61, 0x40018
    s_lshl_b32 s51, s50, 1
    s_lshl_b32 s51, 3, s51
    s_and_b32 s101, s56, s51
    s_cmp_eq_u32 s101, s51
    s_cbranch_scc0 L_ypw_14
L_ypwd_14:
    s_lshl_b32 s50, s50, 12
    s_add_u32 s50, s50, s39
    s_waitcnt lgkmcnt(4)
    v_cmp_gt_u32 vcc, s48, v6
    s_cbranch_vccnz L_yps_11
L_ypsd_11:
    ds_add_u32 v254, v255
    s_add_u32 s48, s48, 4
    v_mfma_f32_32x32x16_bf16 v[32:47], v[64:67], v[144:147], v[32:47]
    ds_read_b64_tr_b16 v[80:81], v14 offset:28672
    ds_read_b64_tr_b16 v[82:83], v14 offset:29696
    buffer_load_dwordx4 v[192:195], v1, s[12:15], s50 offen offset:0 sc1
    v_mfma_f32_32x32x16_bf16 v[48:63], v[68:71], v[144:147], v[48:63]
    ds_read_b64_tr_b16 v[84:85], v15 offset:28672
    ds_read_b64_tr_b16 v[86:87], v15 offset:29696
    s_waitcnt lgkmcnt(5)
    v_mfma_f32_32x32x16_bf16 v[32:47], v[72:75], v[148:151], v[32:47]
    ds_read_b64_tr_b16 v[88:89], v14 offset:30720
    ds_read_b64_tr_b16 v[90:91], v14 offset:31744
    buffer_load_dwordx4 v[196:199], v1, s[12:15], s50 offen offset:1024 sc1
    v_mfma_f32_32x32x16_bf16 v[48:63], v[76:79], v[148:151], v[48:63]
    ds_read_b64_tr_b16 v[92:93], v15 offset:30720
    ds_read_b64_tr_b16 v[94:95], v15 offset:31744
    s_bfe_u32 s44, s60, 0x40010
    s_add_u32 m0, s40, 57344
    s_lshl_b32 s44, s44, 17
    buffer_load_dwordx4 v10, s[52:55], s44 offen lds
    buffer_load_dwordx4 v9, s[52:55], s44 offen offset:1024 lds
    s_waitcnt lgkmcnt(4)
    v_mfma_f32_32x32x16_bf16 v[32:47], v[80:83], v[152:155], v[32:47]
    ds_read_b64_tr_b16 v[64:65], v14 offset:32768
    ds_read_b64_tr_b16 v[66:67], v14 offset:33792
    buffer_load_dwordx4 v[200:203], v1, s[12:15], s50 offen offset:2048 sc1
    v_mfma_f32_32x32x16_bf16 v[48:63], v[84:87], v[152:155], v[48:63]
    ds_read_b64_tr_b16 v[68:69], v15 offset:32768
    ds_read_b64_tr_b16 v[70:71], v15 offset:33792
    s_waitcnt lgkmcnt(4)
    v_mfma_f32_32x32x16_bf16 v[32:47], v[88:91], v[156:159], v[32:47]
    ds_read_b64_tr_b16 v[72:73], v14 offset:34816
    ds_read_b64_tr_b16 v[74:75], v14 offset:35840
    buffer_load_dwordx4 v[204:207], v1, s[12:15], s50 offen offset:3072 sc1
    v_mfma_f32_32x32x16_bf16 v[48:63], v[92:95], v[156:159], v[48:63]
    ds_read_b64_tr_b16 v[76:77], v15 offset:34816
    ds_read_b64_tr_b16 v[78:79], v15 offset:35840
    s_bfe_u32 s44, s60, 0x40014
    s_add_u32 m0, s40, 65536
    s_lshl_b32 s44, s44, 17
    buffer_load_dwordx4 v10, s[52:55], s44 offen lds
    buffer_load_dwordx4 v9, s[52:55], s44 offen offset:1024 lds
    s_waitcnt vmcnt(14)
    s_bfe_u32 s50, s61, 0x4001c
    s_lshl_b32 s51, s50, 1
    s_lshl_b32 s51, 3, s51
    s_and_b32 s101, s56, s51
    s_cmp_eq_u32 s101, s51
    s_cbranch_scc0 L_ypw_15
L_ypwd_15:
    s_lshl_b32 s50, s50, 12
    s_add_u32 s50, s50, s39
    s_waitcnt lgkmcnt(4)
    v_mfma_f32_32x32x16_bf16 v[32:47], v[64:67], v[160:163], v[32:47]
    ds_read_b64_tr_b16 v[80:81], v14 offset:36864
    ds_read_b64_tr_b16 v[82:83], v14 offset:37888
    buffer_load_dwordx4 v[208:211], v1, s[12:15], s50 offen offset:0 sc1
    v_mfma_f32_32x32x16_bf16 v[48:63], v[68:71], v[160:163], v[48:63]
    ds_read_b64_tr_b16 v[84:85], v15 offset:36864
    ds_read_b64_tr_b16 v[86:87], v15 offset:37888
    s_waitcnt lgkmcnt(4)
    v_mfma_f32_32x32x16_bf16 v[32:47], v[72:75], v[164:167], v[32:47]
    ds_read_b64_tr_b16 v[88:89], v14 offset:38912
    ds_read_b64_tr_b16 v[90:91], v14 offset:39936
    buffer_load_dwordx4 v[212:215], v1, s[12:15], s50 offen offset:1024 sc1
    v_mfma_f32_32x32x16_bf16 v[48:63], v[76:79], v[164:167], v[48:63]
    ds_read_b64_tr_b16 v[92:93], v15 offset:38912
    ds_read_b64_tr_b16 v[94:95], v15 offset:39936
    ds_read_b32 v6, v254
    s_waitcnt lgkmcnt(5)
    v_mfma_f32_32x32x16_bf16 v[32:47], v[80:83], v[168:171], v[32:47]
    ds_read_b64_tr_b16 v[64:65], v12 offset:0
    ds_read_b64_tr_b16 v[66:67], v12 offset:1024
    buffer_load_dwordx4 v[216:219], v1, s[12:15], s50 offen offset:2048 sc1
    v_mfma_f32_32x32x16_bf16 v[48:63], v[84:87], v[168:171], v[48:63]
    ds_read_b64_tr_b16 v[68:69], v13 offset:0
    ds_read_b64_tr_b16 v[70:71], v13 offset:1024
    s_waitcnt lgkmcnt(5)
    v_mfma_f32_32x32x16_bf16 v[32:47], v[88:91], v[172:175], v[32:47]
    ds_read_b64_tr_b16 v[72:73], v12 offset:2048
    ds_read_b64_tr_b16 v[74:75], v12 offset:3072
    buffer_load_dwordx4 v[220:223], v1, s[12:15], s50 offen offset:3072 sc1
    v_mfma_f32_32x32x16_bf16 v[48:63], v[92:95], v[172:175], v[48:63]
    ds_read_b64_tr_b16 v[76:77], v13 offset:2048
    ds_read_b64_tr_b16 v[78:79], v13 offset:3072
    s_waitcnt vmcnt(12)
    s_waitcnt lgkmcnt(4)
    v_cmp_gt_u32 vcc, s48, v6
    s_cbranch_vccnz L_yps_13
L_ypsd_13:
    ds_add_u32 v254, v255
    s_add_u32 s48, s48, 4
    v_mfma_f32_32x32x16_bf16 v[32:47], v[64:67], v[176:179], v[32:47]
    ds_read_b64_tr_b16 v[80:81], v12 offset:4096
    ds_read_b64_tr_b16 v[82:83], v12 offset:5120
    v_mfma_f32_32x32x16_bf16 v[48:63], v[68:71], v[176:179], v[48:63]
    ds_read_b64_tr_b16 v[84:85], v13 offset:4096
    ds_read_b64_tr_b16 v[86:87], v13 offset:5120
    s_waitcnt lgkmcnt(5)
    v_mfma_f32_32x32x16_bf16 v[32:47], v[72:75], v[180:183], v[32:47]
    ds_read_b64_tr_b16 v[88:89], v12 offset:6144
    ds_read_b64_tr_b16 v[90:91], v12 offset:7168
    v_mfma_f32_32x32x16_bf16 v[48:63], v[76:79], v[180:183], v[48:63]
    ds_read_b64_tr_b16 v[92:93], v13 offset:6144
    ds_read_b64_tr_b16 v[94:95], v13 offset:7168
    s_bfe_u32 s44, s60, 0x40018
    s_add_u32 m0, s40, 73728
    s_lshl_b32 s44, s44, 17
    buffer_load_dwordx4 v10, s[52:55], s44 offen lds
    buffer_load_dwordx4 v9, s[52:55], s44 offen offset:1024 lds
    s_waitcnt lgkmcnt(4)
    v_mfma_f32_32x32x16_bf16 v[32:47], v[80:83], v[184:187], v[32:47]
    ds_read_b64_tr_b16 v[64:65], v12 offset:8192
    ds_read_b64_tr_b16 v[66:67], v12 offset:9216
    v_mfma_f32_32x32x16_bf16 v[48:63], v[84:87], v[184:187], v[48:63]
    ds_read_b64_tr_b16 v[68:69], v13 offset:8192
    ds_read_b64_tr_b16 v[70:71], v13 offset:9216
    s_waitcnt lgkmcnt(4)
    v_mfma_f32_32x32x16_bf16 v[32:47], v[88:91], v[188:191], v[32:47]
    ds_read_b64_tr_b16 v[72:73], v12 offset:10240
    ds_read_b64_tr_b16 v[74:75], v12 offset:11264
    v_mfma_f32_32x32x16_bf16 v[48:63], v[92:95], v[188:191], v[48:63]
    ds_read_b64_tr_b16 v[76:77], v13 offset:10240
    ds_read_b64_tr_b16 v[78:79], v13 offset:11264
    s_bfe_u32 s44, s60, 0x4001c
    s_add_u32 m0, s40, 81920
    s_lshl_b32 s44, s44, 17
    buffer_load_dwordx4 v10, s[52:55], s44 offen lds
    buffer_load_dwordx4 v9, s[52:55], s44 offen offset:1024 lds
    s_waitcnt vmcnt(10)
    s_waitcnt lgkmcnt(4)
    v_mfma_f32_32x32x16_bf16 v[32:47], v[64:67], v[192:195], v[32:47]
    ds_read_b64_tr_b16 v[80:81], v12 offset:12288
    ds_read_b64_tr_b16 v[82:83], v12 offset:13312
    v_mfma_f32_32x32x16_bf16 v[48:63], v[68:71], v[192:195], v[48:63]
    ds_read_b64_tr_b16 v[84:85], v13 offset:12288
    ds_read_b64_tr_b16 v[86:87], v13 offset:13312
    s_waitcnt lgkmcnt(4)
    v_mfma_f32_32x32x16_bf16 v[32:47], v[72:75], v[196:199], v[32:47]
    ds_read_b64_tr_b16 v[88:89], v12 offset:14336
    ds_read_b64_tr_b16 v[90:91], v12 offset:15360
    v_mfma_f32_32x32x16_bf16 v[48:63], v[76:79], v[196:199], v[48:63]
    ds_read_b64_tr_b16 v[92:93], v13 offset:14336
    ds_read_b64_tr_b16 v[94:95], v13 offset:15360
    ds_read_b32 v6, v254
    s_waitcnt lgkmcnt(5)
    v_mfma_f32_32x32x16_bf16 v[32:47], v[80:83], v[200:203], v[32:47]
    ds_read_b64_tr_b16 v[64:65], v12 offset:16384
    ds_read_b64_tr_b16 v[66:67], v12 offset:17408
    v_mfma_f32_32x32x16_bf16 v[48:63], v[84:87], v[200:203], v[48:63]
    ds_read_b64_tr_b16 v[68:69], v13 offset:16384
    ds_read_b64_tr_b16 v[70:71], v13 offset:17408
    s_waitcnt lgkmcnt(5)
    v_mfma_f32_32x32x16_bf16 v[32:47], v[88:91], v[204:207], v[32:47]
    ds_read_b64_tr_b16 v[72:73], v12 offset:18432
    ds_read_b64_tr_b16 v[74:75], v12 offset:19456
    v_mfma_f32_32x32x16_bf16 v[48:63], v[92:95], v[204:207], v[48:63]
    ds_read_b64_tr_b16 v[76:77], v13 offset:18432
    ds_read_b64_tr_b16 v[78:79], v13 offset:19456
    s_waitcnt vmcnt(4)
    s_waitcnt lgkmcnt(4)
    v_cmp_gt_u32 vcc, s48, v6
    s_cbranch_vccnz L_yps_15
L_ypsd_15:
    v_mfma_f32_32x32x16_bf16 v[32:47], v[64:67], v[208:211], v[32:47]
    ds_read_b64_tr_b16 v[80:81], v12 offset:20480
    ds_read_b64_tr_b16 v[82:83], v12 offset:21504
    v_mfma_f32_32x32x16_bf16 v[48:63], v[68:71], v[208:211], v[48:63]
    ds_read_b64_tr_b16 v[84:85], v13 offset:20480
    ds_read_b64_tr_b16 v[86:87], v13 offset:21504
    s_waitcnt lgkmcnt(4)
    v_mfma_f32_32x32x16_bf16 v[32:47], v[72:75], v[212:215], v[32:47]
    ds_read_b64_tr_b16 v[88:89], v12 offset:22528
    ds_read_b64_tr_b16 v[90:91], v12 offset:23552
    v_mfma_f32_32x32x16_bf16 v[48:63], v[76:79], v[212:215], v[48:63]
    ds_read_b64_tr_b16 v[92:93], v13 offset:22528
    ds_read_b64_tr_b16 v[94:95], v13 offset:23552
    s_bfe_u32 s44, s61, 0x40000
    s_add_u32 m0, s40, 90112
    s_lshl_b32 s44, s44, 17
    buffer_load_dwordx4 v10, s[52:55], s44 offen lds
    buffer_load_dwordx4 v9, s[52:55], s44 offen offset:1024 lds
    s_waitcnt lgkmcnt(4)
    v_mfma_f32_32x32x16_bf16 v[32:47], v[80:83], v[216:219], v[32:47]
    v_mfma_f32_32x32x16_bf16 v[48:63], v[84:87], v[216:219], v[48:63]
    s_waitcnt lgkmcnt(0)
    v_mfma_f32_32x32x16_bf16 v[32:47], v[88:91], v[220:223], v[32:47]
    v_mfma_f32_32x32x16_bf16 v[48:63], v[92:95], v[220:223], v[48:63]
    s_bfe_u32 s44, s61, 0x40004
    s_add_u32 m0, s40, 98304
    s_lshl_b32 s44, s44, 17
    buffer_load_dwordx4 v10, s[52:55], s44 offen lds
    buffer_load_dwordx4 v9, s[52:55], s44 offen offset:1024 lds
    s_mov_b32 s50, s58
    s_nop 9
    v_cvt_pk_bf16_f32 v32, v32, v33
    v_cvt_pk_bf16_f32 v33, v34, v35
    v_cvt_pk_bf16_f32 v34, v36, v37
    v_cvt_pk_bf16_f32 v35, v38, v39
    v_cvt_pk_bf16_f32 v36, v40, v41
    v_cvt_pk_bf16_f32 v37, v42, v43
    v_cvt_pk_bf16_f32 v38, v44, v45
    v_cvt_pk_bf16_f32 v39, v46, v47
    ds_write_b128 v16, v[32:35]
    ds_write_b128 v17, v[36:39]
    v_cvt_pk_bf16_f32 v48, v48, v49
    v_cvt_pk_bf16_f32 v49, v50, v51
    v_cvt_pk_bf16_f32 v50, v52, v53
    v_cvt_pk_bf16_f32 v51, v54, v55
    v_cvt_pk_bf16_f32 v52, v56, v57
    v_cvt_pk_bf16_f32 v53, v58, v59
    v_cvt_pk_bf16_f32 v54, v60, v61
    v_cvt_pk_bf16_f32 v55, v62, v63
    ds_write_b128 v18, v[48:51]
    ds_write_b128 v19, v[52:55]
    ds_read_b128 v[64:67], v20 offset:0
    ds_read_b128 v[68:71], v20 offset:1024
    ds_read_b128 v[72:75], v20 offset:2048
    ds_read_b128 v[76:79], v20 offset:3072
    s_waitcnt lgkmcnt(3)
    buffer_store_dwordx4 v[64:67], v11, s[8:11], s50 offen sc1
    s_add_u32 s50, s50, 0x8000
    s_waitcnt lgkmcnt(2)
    buffer_store_dwordx4 v[68:71], v11, s[8:11], s50 offen sc1
    s_add_u32 s50, s50, 0x8000
    s_waitcnt lgkmcnt(1)
    buffer_store_dwordx4 v[72:75], v11, s[8:11], s50 offen sc1
    s_add_u32 s50, s50, 0x8000
    s_waitcnt lgkmcnt(0)
    buffer_store_dwordx4 v[76:79], v11, s[8:11], s50 offen sc1
    s_add_u32 s50, s50, 0x8000
    s_mov_b32 s56, 0
    s_add_u32 s58, s58, 2048
    s_add_u32 s39, s39, 4194304
    s_add_u32 s49, s49, 131072
    s_setprio 0
    s_mov_b32 s100, 4194304
L_yp_wx:
    ds_read_b32 v6, v21
    s_waitcnt lgkmcnt(0)
    v_cmp_le_u32 vcc, 6, v6
    s_cbranch_vccnz L_yp_go0
    s_sleep 8
    s_sub_u32 s100, s100, 1
    s_cbranch_scc0 L_yp_wx
L_yp_go0:
    s_sleep 0
    s_bfe_u32 s50, s60, 0x40000
    s_lshl_b32 s51, s50, 1
    s_lshl_b32 s51, 3, s51
    s_and_b32 s101, s56, s51
    s_cmp_eq_u32 s101, s51
    s_cbranch_scc0 L_ypw_16
L_ypwd_16:
    s_lshl_b32 s50, s50, 12
    s_add_u32 s50, s50, s39
    buffer_load_dwordx4 v[96:99], v1, s[12:15], s50 offen offset:0 sc1
    buffer_load_dwordx4 v[100:103], v1, s[12:15], s50 offen offset:1024 sc1
    buffer_load_dwordx4 v[104:107], v1, s[12:15], s50 offen offset:2048 sc1
    buffer_load_dwordx4 v[108:111], v1, s[12:15], s50 offen offset:3072 sc1
    s_bfe_u32 s50, s60, 0x40004
    s_lshl_b32 s51, s50, 1
    s_lshl_b32 s51, 3, s51
    s_and_b32 s101, s56, s51
    s_cmp_eq_u32 s101, s51
    s_cbranch_scc0 L_ypw_17
L_ypwd_17:
    s_lshl_b32 s50, s50, 12
    s_add_u32 s50, s50, s39
    buffer_load_dwordx4 v[112:115], v1, s[12:15], s50 offen offset:0 sc1
    buffer_load_dwordx4 v[116:119], v1, s[12:15], s50 offen offset:1024 sc1
    buffer_load_dwordx4 v[120:123], v1, s[12:15], s50 offen offset:2048 sc1
    buffer_load_dwordx4 v[124:127], v1, s[12:15], s50 offen offset:3072 sc1
    s_bfe_u32 s50, s60, 0x40008
    s_lshl_b32 s51, s50, 1
    s_lshl_b32 s51, 3, s51
    s_and_b32 s101, s56, s51
    s_cmp_eq_u32 s101, s51
    s_cbranch_scc0 L_ypw_18
L_ypwd_18:
    s_lshl_b32 s50, s50, 12
    s_add_u32 s50, s50, s39
    buffer_load_dwordx4 v[128:131], v1, s[12:15], s50 offen offset:0 sc1
    buffer_load_dwordx4 v[132:135], v1, s[12:15], s50 offen offset:1024 sc1
    buffer_load_dwordx4 v[136:139], v1, s[12:15], s50 offen offset:2048 sc1
    buffer_load_dwordx4 v[140:143], v1, s[12:15], s50 offen offset:3072 sc1
    s_setprio 2
    v_mov_b32 v32, 0
    v_mov_b32 v33, 0
    v_mov_b32 v34, 0
    v_mov_b32 v35, 0
    v_mov_b32 v36, 0
    v_mov_b32 v37, 0
    v_mov_b32 v38, 0
    v_mov_b32 v39, 0
    v_mov_b32 v40, 0
    v_mov_b32 v41, 0
    v_mov_b32 v42, 0
    v_mov_b32 v43, 0
    v_mov_b32 v44, 0
    v_mov_b32 v45, 0
    v_mov_b32 v46, 0
    v_mov_b32 v47, 0
    v_mov_b32 v48, 0
    v_mov_b32 v49, 0
    v_mov_b32 v50, 0
    v_mov_b32 v51, 0
    v_mov_b32 v52, 0
    v_mov_b32 v53, 0
    v_mov_b32 v54, 0
    v_mov_b32 v55, 0
    v_mov_b32 v56, 0
    v_mov_b32 v57, 0
    v_mov_b32 v58, 0
    v_mov_b32 v59, 0
    v_mov_b32 v60, 0
    v_mov_b32 v61, 0
    v_mov_b32 v62, 0
    v_mov_b32 v63, 0
    s_waitcnt vmcnt(12)
    ds_add_u32 v254, v255
    s_add_u32 s48, s48, 4
    s_mov_b32 s100, 4194304
L_spin_p11:
    ds_read_b32 v6, v254
    s_waitcnt lgkmcnt(0)
    v_cmp_le_u32 vcc, s48, v6
    s_cbranch_vccnz L_spind_p11
    s_sleep 1
    s_sub_u32 s100, s100, 1
    s_cbranch_scc0 L_spin_p11
L_spind_p11:
    s_setprio 0
    ds_read_b64_tr_b16 v[64:65], v12 offset:24576
    ds_read_b64_tr_b16 v[66:67], v12 offset:25600
    ds_read_b64_tr_b16 v[68:69], v13 offset:24576
    ds_read_b64_tr_b16 v[70:71], v13 offset:25600
    ds_read_b64_tr_b16 v[72:73], v12 offset:26624
    ds_read_b64_tr_b16 v[74:75], v12 offset:27648
    ds_read_b64_tr_b16 v[76:77], v13 offset:26624
    ds_read_b64_tr_b16 v[78:79], v13 offset:27648
    s_waitcnt vmcnt(8)
    s_bfe_u32 s50, s60, 0x4000c
    s_lshl_b32 s51, s50, 1
    s_lshl_b32 s51, 3, s51
    s_and_b32 s101, s56, s51
    s_cmp_eq_u32 s101, s51
    s_cbranch_scc0 L_ypw_19
L_ypwd_19:
    s_lshl_b32 s50, s50, 12
    s_add_u32 s50, s50, s39
    s_waitcnt lgkmcnt(4)
    v_mfma_f32_32x32x16_bf16 v[32:47], v[64:67], v[96:99], v[32:47]
    ds_read_b64_tr_b16 v[80:81], v12 offset:28672
    ds_read_b64_tr_b16 v[82:83], v12 offset:29696
    buffer_load_dwordx4 v[144:147], v1, s[12:15], s50 offen offset:0 sc1
    v_mfma_f32_32x32x16_bf16 v[48:63], v[68:71], v[96:99], v[48:63]
    ds_read_b64_tr_b16 v[84:85], v13 offset:28672
    ds_read_b64_tr_b16 v[86:87], v13 offset:29696
    s_waitcnt lgkmcnt(4)
    v_mfma_f32_32x32x16_bf16 v[32:47], v[72:75], v[100:103], v[32:47]
    ds_read_b64_tr_b16 v[88:89], v12 offset:30720
    ds_read_b64_tr_b16 v[90:91], v12 offset:31744
    buffer_load_dwordx4 v[148:151], v1, s[12:15], s50 offen offset:1024 sc1
    v_mfma_f32_32x32x16_bf16 v[48:63], v[76:79], v[100:103], v[48:63]
    ds_read_b64_tr_b16 v[92:93], v13 offset:30720
    ds_read_b64_tr_b16 v[94:95], v13 offset:31744
    s_bfe_u32 s44, s61, 0x40008
    s_add_u32 m0, s40, 0
    s_lshl_b32 s44, s44, 17
    buffer_load_dwordx4 v10, s[52:55], s44 offen lds
    buffer_load_dwordx4 v9, s[52:55], s44 offen offset:1024 lds
    s_waitcnt lgkmcnt(4)
    v_mfma_f32_32x32x16_bf16 v[32:47], v[80:83], v[104:107], v[32:47]
    ds_read_b64_tr_b16 v[64:65], v12 offset:32768
    ds_read_b64_tr_b16 v[66:67], v12 offset:33792
    buffer_load_dwordx4 v[152:155], v1, s[12:15], s50 offen offset:2048 sc1
    v_mfma_f32_32x32x16_bf16 v[48:63], v[84:87], v[104:107], v[48:63]
    ds_read_b64_tr_b16 v[68:69], v13 offset:32768
    ds_read_b64_tr_b16 v[70:71], v13 offset:33792
    s_waitcnt lgkmcnt(4)
    v_mfma_f32_32x32x16_bf16 v[32:47], v[88:91], v[108:111], v[32:47]
    ds_read_b64_tr_b16 v[72:73], v12 offset:34816
    ds_read_b64_tr_b16 v[74:75], v12 offset:35840
    buffer_load_dwordx4 v[156:159], v1, s[12:15], s50 offen offset:3072 sc1
    v_mfma_f32_32x32x16_bf16 v[48:63], v[92:95], v[108:111], v[48:63]
    ds_read_b64_tr_b16 v[76:77], v13 offset:34816
    ds_read_b64_tr_b16 v[78:79], v13 offset:35840
    s_bfe_u32 s44, s61, 0x4000c
    s_add_u32 m0, s40, 8192
    s_lshl_b32 s44, s44, 17
    buffer_load_dwordx4 v10, s[52:55], s44 offen lds
    buffer_load_dwordx4 v9, s[52:55], s44 offen offset:1024 lds
    s_waitcnt vmcnt(12)
    s_bfe_u32 s50, s60, 0x40010
    s_lshl_b32 s51, s50, 1
    s_lshl_b32 s51, 3, s51
    s_and_b32 s101, s56, s51
    s_cmp_eq_u32 s101, s51
    s_cbranch_scc0 L_ypw_20
L_ypwd_20:
    s_lshl_b32 s50, s50, 12
    s_add_u32 s50, s50, s39
    s_waitcnt lgkmcnt(4)
    ds_add_u32 v254, v255
    s_add_u32 s48, s48, 4
    v_mfma_f32_32x32x16_bf16 v[32:47], v[64:67], v[112:115], v[32:47]
    ds_read_b64_tr_b16 v[80:81], v12 offset:36864
    ds_read_b64_tr_b16 v[82:83], v12 offset:37888
    buffer_load_dwordx4 v[160:163], v1, s[12:15], s50 offen offset:0 sc1
    v_mfma_f32_32x32x16_bf16 v[48:63], v[68:71], v[112:115], v[48:63]
    ds_read_b64_tr_b16 v[84:85], v13 offset:36864
    ds_read_b64_tr_b16 v[86:87], v13 offset:37888
    s_waitcnt lgkmcnt(5)
    v_mfma_f32_32x32x16_bf16 v[32:47], v[72:75], v[116:119], v[32:47]
    ds_read_b64_tr_b16 v[88:89], v12 offset:38912
    ds_read_b64_tr_b16 v[90:91], v12 offset:39936
    buffer_load_dwordx4 v[164:167], v1, s[12:15], s50 offen offset:1024 sc1
    v_mfma_f32_32x32x16_bf16 v[48:63], v[76:79], v[116:119], v[48:63]
    ds_read_b64_tr_b16 v[92:93], v13 offset:38912
    ds_read_b64_tr_b16 v[94:95], v13 offset:39936
    s_bfe_u32 s44, s61, 0x40010
    s_add_u32 m0, s40, 16384
    s_lshl_b32 s44, s44, 17
    buffer_load_dwordx4 v10, s[52:55], s44 offen lds
    buffer_load_dwordx4 v9, s[52:55], s44 offen offset:1024 lds
    s_waitcnt lgkmcnt(4)
    v_mfma_f32_32x32x16_bf16 v[32:47], v[80:83], v[120:123], v[32:47]
    ds_read_b64_tr_b16 v[64:65], v12 offset:40960
    ds_read_b64_tr_b16 v[66:67], v12 offset:41984
    buffer_load_dwordx4 v[168:171], v1, s[12:15], s50 offen offset:2048 sc1
    v_mfma_f32_32x32x16_bf16 v[48:63], v[84:87], v[120:123], v[48:63]
    ds_read_b64_tr_b16 v[68:69], v13 offset:40960
    ds_read_b64_tr_b16 v[70:71], v13 offset:41984
    s_waitcnt lgkmcnt(4)
    v_mfma_f32_32x32x16_bf16 v[32:47], v[88:91], v[124:127], v[32:47]
    ds_read_b64_tr_b16 v[72:73], v12 offset:43008
    ds_read_b64_tr_b16 v[74:75], v12 offset:44032
    buffer_load_dwordx4 v[172:175], v1, s[12:15], s50 offen offset:3072 sc1
    v_mfma_f32_32x32x16_bf16 v[48:63], v[92:95], v[124:127], v[48:63]
    ds_read_b64_tr_b16 v[76:77], v13 offset:43008
    ds_read_b64_tr_b16 v[78:79], v13 offset:44032
    s_waitcnt vmcnt(14)
    s_bfe_u32 s50, s60, 0x40014
    s_lshl_b32 s51, s50, 1
    s_lshl_b32 s51, 3, s51
    s_and_b32 s101, s56, s51
    s_cmp_eq_u32 s101, s51
    s_cbranch_scc0 L_ypw_21
L_ypwd_21:
    s_lshl_b32 s50, s50, 12
    s_add_u32 s50, s50, s39
    s_waitcnt lgkmcnt(4)
    v_mfma_f32_32x32x16_bf16 v[32:47], v[64:67], v[128:131], v[32:47]
    ds_read_b64_tr_b16 v[80:81], v12 offset:45056
    ds_read_b64_tr_b16 v[82:83], v12 offset:46080
    buffer_load_dwordx4 v[176:179], v1, s[12:15], s50 offen offset:0 sc1
    v_mfma_f32_32x32x16_bf16 v[48:63], v[68:71], v[128:131], v[48:63]
    ds_read_b64_tr_b16 v[84:85], v13 offset:45056
    ds_read_b64_tr_b16 v[86:87], v13 offset:46080
    s_waitcnt lgkmcnt(4)
    v_mfma_f32_32x32x16_bf16 v[32:47], v[72:75], v[132:135], v[32:47]
    ds_read_b64_tr_b16 v[88:89], v12 offset:47104
    ds_read_b64_tr_b16 v[90:91], v12 offset:48128
    buffer_load_dwordx4 v[180:183], v1, s[12:15], s50 offen offset:1024 sc1
    v_mfma_f32_32x32x16_bf16 v[48:63], v[76:79], v[132:135], v[48:63]
    ds_read_b64_tr_b16 v[92:93], v13 offset:47104
    ds_read_b64_tr_b16 v[94:95], v13 offset:48128
    ds_read_b32 v6, v254
    s_waitcnt lgkmcnt(5)
    v_mfma_f32_32x32x16_bf16 v[32:47], v[80:83], v[136:139], v[32:47]
    ds_read_b64_tr_b16 v[64:65], v12 offset:49152
    ds_read_b64_tr_b16 v[66:67], v12 offset:50176
    buffer_load_dwordx4 v[184:187], v1, s[12:15], s50 offen offset:2048 sc1
    v_mfma_f32_32x32x16_bf16 v[48:63], v[84:87], v[136:139], v[48:63]
    ds_read_b64_tr_b16 v[68:69], v13 offset:49152
    ds_read_b64_tr_b16 v[70:71], v13 offset:50176
    s_waitcnt lgkmcnt(5)
    v_mfma_f32_32x32x16_bf16 v[32:47], v[88:91], v[140:143], v[32:47]
    ds_read_b64_tr_b16 v[72:73], v12 offset:51200
    ds_read_b64_tr_b16 v[74:75], v12 offset:52224
    buffer_load_dwordx4 v[188:191], v1, s[12:15], s50 offen offset:3072 sc1
    v_mfma_f32_32x32x16_bf16 v[48:63], v[92:95], v[140:143], v[48:63]
    ds_read_b64_tr_b16 v[76:77], v13 offset:51200
    ds_read_b64_tr_b16 v[78:79], v13 offset:52224
    s_waitcnt vmcnt(12)
    s_bfe_u32 s50, s60, 0x40018
    s_lshl_b32 s51, s50, 1
    s_lshl_b32 s51, 3, s51
    s_and_b32 s101, s56, s51
    s_cmp_eq_u32 s101, s51
    s_cbranch_scc0 L_ypw_22
L_ypwd_22:
    s_lshl_b32 s50, s50, 12
    s_add_u32 s50, s50, s39
    s_waitcnt lgkmcnt(4)
    v_cmp_gt_u32 vcc, s48, v6
    s_cbranch_vccnz L_yps_19
L_ypsd_19:
    ds_add_u32 v254, v255
    s_add_u32 s48, s48, 4
    v_mfma_f32_32x32x16_bf16 v[32:47], v[64:67], v[144:147], v[32:47]
    ds_read_b64_tr_b16 v[80:81], v12 offset:53248
    ds_read_b64_tr_b16 v[82:83], v12 offset:54272
    buffer_load_dwordx4 v[192:195], v1, s[12:15], s50 offen offset:0 sc1
    v_mfma_f32_32x32x16_bf16 v[48:63], v[68:71], v[144:147], v[48:63]
    ds_read_b64_tr_b16 v[84:85], v13 offset:53248
    ds_read_b64_tr_b16 v[86:87], v13 offset:54272
    s_waitcnt lgkmcnt(5)
    v_mfma_f32_32x32x16_bf16 v[32:47], v[72:75], v[148:151], v[32:47]
    ds_read_b64_tr_b16 v[88:89], v12 offset:55296
    ds_read_b64_tr_b16 v[90:91], v12 offset:56320
    buffer_load_dwordx4 v[196:199], v1, s[12:15], s50 offen offset:1024 sc1
    v_mfma_f32_32x32x16_bf16 v[48:63], v[76:79], v[148:151], v[48:63]
    ds_read_b64_tr_b16 v[92:93], v13 offset:55296
    ds_read_b64_tr_b16 v[94:95], v13 offset:56320
    s_bfe_u32 s44, s61, 0x40014
    s_add_u32 m0, s40, 24576
    s_lshl_b32 s44, s44, 17
    buffer_load_dwordx4 v10, s[52:55], s44 offen lds
    buffer_load_dwordx4 v9, s[52:55], s44 offen offset:1024 lds
    s_waitcnt lgkmcnt(4)
    v_mfma_f32_32x32x16_bf16 v[32:47], v[80:83], v[152:155], v[32:47]
    ds_read_b64_tr_b16 v[64:65], v12 offset:57344
    ds_read_b64_tr_b16 v[66:67], v12 offset:58368
    buffer_load_dwordx4 v[200:203], v1, s[12:15], s50 offen offset:2048 sc1
    v_mfma_f32_32x32x16_bf16 v[48:63], v[84:87], v[152:155], v[48:63]
    ds_read_b64_tr_b16 v[68:69], v13 offset:57344
    ds_read_b64_tr_b16 v[70:71], v13 offset:58368
    s_waitcnt lgkmcnt(4)
    v_mfma_f32_32x32x16_bf16 v[32:47], v[88:91], v[156:159], v[32:47]
    ds_read_b64_tr_b16 v[72:73], v12 offset:59392
    ds_read_b64_tr_b16 v[74:75], v12 offset:60416
    buffer_load_dwordx4 v[204:207], v1, s[12:15], s50 offen offset:3072 sc1
    v_mfma_f32_32x32x16_bf16 v[48:63], v[92:95], v[156:159], v[48:63]
    ds_read_b64_tr_b16 v[76:77], v13 offset:59392
    ds_read_b64_tr_b16 v[78:79], v13 offset:60416
    s_waitcnt vmcnt(10)
    s_bfe_u32 s50, s60, 0x4001c
    s_lshl_b32 s51, s50, 1
    s_lshl_b32 s51, 3, s51
    s_and_b32 s101, s56, s51
    s_cmp_eq_u32 s101, s51
    s_cbranch_scc0 L_ypw_23
L_ypwd_23:
    s_lshl_b32 s50, s50, 12
    s_add_u32 s50, s50, s39
    s_waitcnt lgkmcnt(4)
    v_mfma_f32_32x32x16_bf16 v[32:47], v[64:67], v[160:163], v[32:47]
    ds_read_b64_tr_b16 v[80:81], v12 offset:61440
    ds_read_b64_tr_b16 v[82:83], v12 offset:62464
    buffer_load_dwordx4 v[208:211], v1, s[12:15], s50 offen offset:0 sc1
    v_mfma_f32_32x32x16_bf16 v[48:63], v[68:71], v[160:163], v[48:63]
    ds_read_b64_tr_b16 v[84:85], v13 offset:61440
    ds_read_b64_tr_b16 v[86:87], v13 offset:62464
    s_waitcnt lgkmcnt(4)
    v_mfma_f32_32x32x16_bf16 v[32:47], v[72:75], v[164:167], v[32:47]
    ds_read_b64_tr_b16 v[88:89], v12 offset:63488
    ds_read_b64_tr_b16 v[90:91], v12 offset:64512
    buffer_load_dwordx4 v[212:215], v1, s[12:15], s50 offen offset:1024 sc1
    v_mfma_f32_32x32x16_bf16 v[48:63], v[76:79], v[164:167], v[48:63]
    ds_read_b64_tr_b16 v[92:93], v13 offset:63488
    ds_read_b64_tr_b16 v[94:95], v13 offset:64512
    ds_read_b32 v6, v254
    s_waitcnt lgkmcnt(5)
    v_mfma_f32_32x32x16_bf16 v[32:47], v[80:83], v[168:171], v[32:47]
    ds_read_b64_tr_b16 v[64:65], v14 offset:0
    ds_read_b64_tr_b16 v[66:67], v14 offset:1024
    buffer_load_dwordx4 v[216:219], v1, s[12:15], s50 offen offset:2048 sc1
    v_mfma_f32_32x32x16_bf16 v[48:63], v[84:87], v[168:171], v[48:63]
    ds_read_b64_tr_b16 v[68:69], v15 offset:0
    ds_read_b64_tr_b16 v[70:71], v15 offset:1024
    s_waitcnt lgkmcnt(5)
    v_mfma_f32_32x32x16_bf16 v[32:47], v[88:91], v[172:175], v[32:47]
    ds_read_b64_tr_b16 v[72:73], v14 offset:2048
    ds_read_b64_tr_b16 v[74:75], v14 offset:3072
    buffer_load_dwordx4 v[220:223], v1, s[12:15], s50 offen offset:3072 sc1
    v_mfma_f32_32x32x16_bf16 v[48:63], v[92:95], v[172:175], v[48:63]
    ds_read_b64_tr_b16 v[76:77], v15 offset:2048
    ds_read_b64_tr_b16 v[78:79], v15 offset:3072
    s_waitcnt vmcnt(10)
    s_bfe_u32 s50, s61, 0x40000
    s_lshl_b32 s51, s50, 1
    s_lshl_b32 s51, 3, s51
    s_and_b32 s101, s56, s51
    s_cmp_eq_u32 s101, s51
    s_cbranch_scc0 L_ypw_24
L_ypwd_24:
    s_lshl_b32 s50, s50, 12
    s_add_u32 s50, s50, s39
    s_waitcnt lgkmcnt(4)
    v_cmp_gt_u32 vcc, s48, v6
    s_cbranch_vccnz L_yps_21
L_ypsd_21:
    ds_add_u32 v254, v255
    s_add_u32 s48, s48, 4
    v_mfma_f32_32x32x16_bf16 v[32:47], v[64:67], v[176:179], v[32:47]
    ds_read_b64_tr_b16 v[80:81], v14 offset:4096
    ds_read_b64_tr_b16 v[82:83], v14 offset:5120
    buffer_load_dwordx4 v[96:99], v1, s[12:15], s50 offen offset:0 sc1
    v_mfma_f32_32x32x16_bf16 v[48:63], v[68:71], v[176:179], v[48:63]
    ds_read_b64_tr_b16 v[84:85], v15 offset:4096
    ds_read_b64_tr_b16 v[86:87], v15 offset:5120
    s_waitcnt lgkmcnt(5)
    v_mfma_f32_32x32x16_bf16 v[32:47], v[72:75], v[180:183], v[32:47]
    ds_read_b64_tr_b16 v[88:89], v14 offset:6144
    ds_read_b64_tr_b16 v[90:91], v14 offset:7168
    buffer_load_dwordx4 v[100:103], v1, s[12:15], s50 offen offset:1024 sc1
    v_mfma_f32_32x32x16_bf16 v[48:63], v[76:79], v[180:183], v[48:63]
    ds_read_b64_tr_b16 v[92:93], v15 offset:6144
    ds_read_b64_tr_b16 v[94:95], v15 offset:7168
    s_bfe_u32 s44, s61, 0x40018
    s_add_u32 m0, s40, 32768
    s_lshl_b32 s44, s44, 17
    buffer_load_dwordx4 v10, s[52:55], s44 offen lds
    buffer_load_dwordx4 v9, s[52:55], s44 offen offset:1024 lds
    s_waitcnt lgkmcnt(4)
    v_mfma_f32_32x32x16_bf16 v[32:47], v[80:83], v[184:187], v[32:47]
    ds_read_b64_tr_b16 v[64:65], v14 offset:8192
    ds_read_b64_tr_b16 v[66:67], v14 offset:9216
    buffer_load_dwordx4 v[104:107], v1, s[12:15], s50 offen offset:2048 sc1
    v_mfma_f32_32x32x16_bf16 v[48:63], v[84:87], v[184:187], v[48:63]
    ds_read_b64_tr_b16 v[68:69], v15 offset:8192
    ds_read_b64_tr_b16 v[70:71], v15 offset:9216
    s_waitcnt lgkmcnt(4)
    v_mfma_f32_32x32x16_bf16 v[32:47], v[88:91], v[188:191], v[32:47]
    ds_read_b64_tr_b16 v[72:73], v14 offset:10240
    ds_read_b64_tr_b16 v[74:75], v14 offset:11264
    buffer_load_dwordx4 v[108:111], v1, s[12:15], s50 offen offset:3072 sc1
    v_mfma_f32_32x32x16_bf16 v[48:63], v[92:95], v[188:191], v[48:63]
    ds_read_b64_tr_b16 v[76:77], v15 offset:10240
    ds_read_b64_tr_b16 v[78:79], v15 offset:11264
    s_bfe_u32 s44, s61, 0x4001c
    s_add_u32 m0, s40, 40960
    s_lshl_b32 s44, s44, 17
    buffer_load_dwordx4 v10, s[52:55], s44 offen lds
    buffer_load_dwordx4 v9, s[52:55], s44 offen offset:1024 lds
    s_waitcnt vmcnt(12)
    s_bfe_u32 s50, s61, 0x40004
    s_lshl_b32 s51, s50, 1
    s_lshl_b32 s51, 3, s51
    s_and_b32 s101, s56, s51
    s_cmp_eq_u32 s101, s51
    s_cbranch_scc0 L_ypw_25
L_ypwd_25:
    s_lshl_b32 s50, s50, 12
    s_add_u32 s50, s50, s39
    s_waitcnt lgkmcnt(4)
    v_mfma_f32_32x32x16_bf16 v[32:47], v[64:67], v[192:195], v[32:47]
    ds_read_b64_tr_b16 v[80:81], v14 offset:12288
    ds_read_b64_tr_b16 v[82:83], v14 offset:13312
    buffer_load_dwordx4 v[112:115], v1, s[12:15], s50 offen offset:0 sc1
    v_mfma_f32_32x32x16_bf16 v[48:63], v[68:71], v[192:195], v[48:63]
    ds_read_b64_tr_b16 v[84:85], v15 offset:12288
    ds_read_b64_tr_b16 v[86:87], v15 offset:13312
    s_waitcnt lgkmcnt(4)
    v_mfma_f32_32x32x16_bf16 v[32:47], v[72:75], v[196:199], v[32:47]
    ds_read_b64_tr_b16 v[88:89], v14 offset:14336
    ds_read_b64_tr_b16 v[90:91], v14 offset:15360
    buffer_load_dwordx4 v[116:119], v1, s[12:15], s50 offen offset:1024 sc1
    v_mfma_f32_32x32x16_bf16 v[48:63], v[76:79], v[196:199], v[48:63]
    ds_read_b64_tr_b16 v[92:93], v15 offset:14336
    ds_read_b64_tr_b16 v[94:95], v15 offset:15360
    ds_read_b32 v6, v254
    s_waitcnt lgkmcnt(5)
    v_mfma_f32_32x32x16_bf16 v[32:47], v[80:83], v[200:203], v[32:47]
    ds_read_b64_tr_b16 v[64:65], v14 offset:16384
    ds_read_b64_tr_b16 v[66:67], v14 offset:17408
    buffer_load_dwordx4 v[120:123], v1, s[12:15], s50 offen offset:2048 sc1
    v_mfma_f32_32x32x16_bf16 v[48:63], v[84:87], v[200:203], v[48:63]
    ds_read_b64_tr_b16 v[68:69], v15 offset:16384
    ds_read_b64_tr_b16 v[70:71], v15 offset:17408
    s_waitcnt lgkmcnt(5)
    v_mfma_f32_32x32x16_bf16 v[32:47], v[88:91], v[204:207], v[32:47]
    ds_read_b64_tr_b16 v[72:73], v14 offset:18432
    ds_read_b64_tr_b16 v[74:75], v14 offset:19456
    buffer_load_dwordx4 v[124:127], v1, s[12:15], s50 offen offset:3072 sc1
    v_mfma_f32_32x32x16_bf16 v[48:63], v[92:95], v[204:207], v[48:63]
    ds_read_b64_tr_b16 v[76:77], v15 offset:18432
    ds_read_b64_tr_b16 v[78:79], v15 offset:19456
    s_waitcnt vmcnt(12)
    s_bfe_u32 s50, s61, 0x40008
    s_lshl_b32 s51, s50, 1
    s_lshl_b32 s51, 3, s51
    s_and_b32 s101, s56, s51
    s_cmp_eq_u32 s101, s51
    s_cbranch_scc0 L_ypw_26
L_ypwd_26:
    s_lshl_b32 s50, s50, 12
    s_add_u32 s50, s50, s39
    s_waitcnt lgkmcnt(4)
    v_cmp_gt_u32 vcc, s48, v6
    s_cbranch_vccnz L_yps_23
L_ypsd_23:
    ds_add_u32 v254, v255
    s_add_u32 s48, s48, 4
    v_mfma_f32_32x32x16_bf16 v[32:47], v[64:67], v[208:211], v[32:47]
    ds_read_b64_tr_b16 v[80:81], v14 offset:20480
    ds_read_b64_tr_b16 v[82:83], v14 offset:21504
    buffer_load_dwordx4 v[128:131], v1, s[12:15], s50 offen offset:0 sc1
    v_mfma_f32_32x32x16_bf16 v[48:63], v[68:71], v[208:211], v[48:63]
    ds_read_b64_tr_b16 v[84:85], v15 offset:20480
    ds_read_b64_tr_b16 v[86:87], v15 offset:21504
    s_waitcnt lgkmcnt(5)
    v_mfma_f32_32x32x16_bf16 v[32:47], v[72:75], v[212:215], v[32:47]
    ds_read_b64_tr_b16 v[88:89], v14 offset:22528
    ds_read_b64_tr_b16 v[90:91], v14 offset:23552
    buffer_load_dwordx4 v[132:135], v1, s[12:15], s50 offen offset:1024 sc1
    v_mfma_f32_32x32x16_bf16 v[48:63], v[76:79], v[212:215], v[48:63]
    ds_read_b64_tr_b16 v[92:93], v15 offset:22528
    ds_read_b64_tr_b16 v[94:95], v15 offset:23552
    s_waitcnt lgkmcnt(4)
    v_mfma_f32_32x32x16_bf16 v[32:47], v[80:83], v[216:219], v[32:47]
    ds_read_b64_tr_b16 v[64:65], v14 offset:24576
    ds_read_b64_tr_b16 v[66:67], v14 offset:25600
    buffer_load_dwordx4 v[136:139], v1, s[12:15], s50 offen offset:2048 sc1
    v_mfma_f32_32x32x16_bf16 v[48:63], v[84:87], v[216:219], v[48:63]
    ds_read_b64_tr_b16 v[68:69], v15 offset:24576
    ds_read_b64_tr_b16 v[70:71], v15 offset:25600
    s_waitcnt lgkmcnt(4)
    v_mfma_f32_32x32x16_bf16 v[32:47], v[88:91], v[220:223], v[32:47]
    ds_read_b64_tr_b16 v[72:73], v14 offset:26624
    ds_read_b64_tr_b16 v[74:75], v14 offset:27648
    buffer_load_dwordx4 v[140:143], v1, s[12:15], s50 offen offset:3072 sc1
    v_mfma_f32_32x32x16_bf16 v[48:63], v[92:95], v[220:223], v[48:63]
    ds_read_b64_tr_b16 v[76:77], v15 offset:26624
    ds_read_b64_tr_b16 v[78:79], v15 offset:27648
    s_waitcnt vmcnt(10)
    s_bfe_u32 s50, s61, 0x4000c
    s_lshl_b32 s51, s50, 1
    s_lshl_b32 s51, 3, s51
    s_and_b32 s101, s56, s51
    s_cmp_eq_u32 s101, s51
    s_cbranch_scc0 L_ypw_27
L_ypwd_27:
    s_lshl_b32 s50, s50, 12
    s_add_u32 s50, s50, s39
    s_waitcnt lgkmcnt(4)
    v_mfma_f32_32x32x16_bf16 v[32:47], v[64:67], v[96:99], v[32:47]
    ds_read_b64_tr_b16 v[80:81], v14 offset:28672
    ds_read_b64_tr_b16 v[82:83], v14 offset:29696
    buffer_load_dwordx4 v[144:147], v1, s[12:15], s50 offen offset:0 sc1
    v_mfma_f32_32x32x16_bf16 v[48:63], v[68:71], v[96:99], v[48:63]
    ds_read_b64_tr_b16 v[84:85], v15 offset:28672
    ds_read_b64_tr_b16 v[86:87], v15 offset:29696
    s_waitcnt lgkmcnt(4)
    v_mfma_f32_32x32x16_bf16 v[32:47], v[72:75], v[100:103], v[32:47]
    ds_read_b64_tr_b16 v[88:89], v14 offset:30720
    ds_read_b64_tr_b16 v[90:91], v14 offset:31744
    buffer_load_dwordx4 v[148:151], v1, s[12:15], s50 offen offset:1024 sc1
    v_mfma_f32_32x32x16_bf16 v[48:63], v[76:79], v[100:103], v[48:63]
    ds_read_b64_tr_b16 v[92:93], v15 offset:30720
    ds_read_b64_tr_b16 v[94:95], v15 offset:31744
    ds_read_b32 v6, v254
    s_waitcnt lgkmcnt(5)
    v_mfma_f32_32x32x16_bf16 v[32:47], v[80:83], v[104:107], v[32:47]
    ds_read_b64_tr_b16 v[64:65], v14 offset:32768
    ds_read_b64_tr_b16 v[66:67], v14 offset:33792
    buffer_load_dwordx4 v[152:155], v1, s[12:15], s50 offen offset:2048 sc1
    v_mfma_f32_32x32x16_bf16 v[48:63], v[84:87], v[104:107], v[48:63]
    ds_read_b64_tr_b16 v[68:69], v15 offset:32768
    ds_read_b64_tr_b16 v[70:71], v15 offset:33792
    s_waitcnt lgkmcnt(5)
    v_mfma_f32_32x32x16_bf16 v[32:47], v[88:91], v[108:111], v[32:47]
    ds_read_b64_tr_b16 v[72:73], v14 offset:34816
    ds_read_b64_tr_b16 v[74:75], v14 offset:35840
    buffer_load_dwordx4 v[156:159], v1, s[12:15], s50 offen offset:3072 sc1
    v_mfma_f32_32x32x16_bf16 v[48:63], v[92:95], v[108:111], v[48:63]
    ds_read_b64_tr_b16 v[76:77], v15 offset:34816
    ds_read_b64_tr_b16 v[78:79], v15 offset:35840
    s_waitcnt vmcnt(8)
    s_bfe_u32 s50, s61, 0x40010
    s_lshl_b32 s51, s50, 1
    s_lshl_b32 s51, 3, s51
    s_and_b32 s101, s56, s51
    s_cmp_eq_u32 s101, s51
    s_cbranch_scc0 L_ypw_28
L_ypwd_28:
    s_lshl_b32 s50, s50, 12
    s_add_u32 s50, s50, s39
    s_waitcnt lgkmcnt(4)
    v_cmp_gt_u32 vcc, s48, v6
    s_cbranch_vccnz L_yps_25
L_ypsd_25:
    ds_add_u32 v254, v255
    s_add_u32 s48, s48, 4
    v_mfma_f32_32x32x16_bf16 v[32:47], v[64:67], v[112:115], v[32:47]
    ds_read_b64_tr_b16 v[80:81], v14 offset:36864
    ds_read_b64_tr_b16 v[82:83], v14 offset:37888
    buffer_load_dwordx4 v[160:163], v1, s[12:15], s50 offen offset:0 sc1
    v_mfma_f32_32x32x16_bf16 v[48:63], v[68:71], v[112:115], v[48:63]
    ds_read_b64_tr_b16 v[84:85], v15 offset:36864
    ds_read_b64_tr_b16 v[86:87], v15 offset:37888
    s_waitcnt lgkmcnt(5)
    v_mfma_f32_32x32x16_bf16 v[32:47], v[72:75], v[116:119], v[32:47]
    ds_read_b64_tr_b16 v[88:89], v14 offset:38912
    ds_read_b64_tr_b16 v[90:91], v14 offset:39936
    buffer_load_dwordx4 v[164:167], v1, s[12:15], s50 offen offset:1024 sc1
    v_mfma_f32_32x32x16_bf16 v[48:63], v[76:79], v[116:119], v[48:63]
    ds_read_b64_tr_b16 v[92:93], v15 offset:38912
    ds_read_b64_tr_b16 v[94:95], v15 offset:39936
    s_waitcnt lgkmcnt(4)
    v_mfma_f32_32x32x16_bf16 v[32:47], v[80:83], v[120:123], v[32:47]
    ds_read_b64_tr_b16 v[64:65], v12 offset:0
    ds_read_b64_tr_b16 v[66:67], v12 offset:1024
    buffer_load_dwordx4 v[168:171], v1, s[12:15], s50 offen offset:2048 sc1
    v_mfma_f32_32x32x16_bf16 v[48:63], v[84:87], v[120:123], v[48:63]
    ds_read_b64_tr_b16 v[68:69], v13 offset:0
    ds_read_b64_tr_b16 v[70:71], v13 offset:1024
    s_waitcnt lgkmcnt(4)
    v_mfma_f32_32x32x16_bf16 v[32:47], v[88:91], v[124:127], v[32:47]
    ds_read_b64_tr_b16 v[72:73], v12 offset:2048
    ds_read_b64_tr_b16 v[74:75], v12 offset:3072
    buffer_load_dwordx4 v[172:175], v1, s[12:15], s50 offen offset:3072 sc1
    v_mfma_f32_32x32x16_bf16 v[48:63], v[92:95], v[124:127], v[48:63]
    ds_read_b64_tr_b16 v[76:77], v13 offset:2048
    ds_read_b64_tr_b16 v[78:79], v13 offset:3072
    s_waitcnt vmcnt(8)
    s_bfe_u32 s50, s61, 0x40014
    s_lshl_b32 s51, s50, 1
    s_lshl_b32 s51, 3, s51
    s_and_b32 s101, s56, s51
    s_cmp_eq_u32 s101, s51
    s_cbranch_scc0 L_ypw_29
L_ypwd_29:
    s_lshl_b32 s50, s50, 12
    s_add_u32 s50, s50, s39
    s_waitcnt lgkmcnt(4)
    v_mfma_f32_32x32x16_bf16 v[32:47], v[64:67], v[128:131], v[32:47]
    ds_read_b64_tr_b16 v[80:81], v12 offset:4096
    ds_read_b64_tr_b16 v[82:83], v12 offset:5120
    buffer_load_dwordx4 v[176:179], v1, s[12:15], s50 offen offset:0 sc1
    v_mfma_f32_32x32x16_bf16 v[48:63], v[68:71], v[128:131], v[48:63]
    ds_read_b64_tr_b16 v[84:85], v13 offset:4096
    ds_read_b64_tr_b16 v[86:87], v13 offset:5120
    s_waitcnt lgkmcnt(4)
    v_mfma_f32_32x32x16_bf16 v[32:47], v[72:75], v[132:135], v[32:47]
    ds_read_b64_tr_b16 v[88:89], v12 offset:6144
    ds_read_b64_tr_b16 v[90:91], v12 offset:7168
    buffer_load_dwordx4 v[180:183], v1, s[12:15], s50 offen offset:1024 sc1
    v_mfma_f32_32x32x16_bf16 v[48:63], v[76:79], v[132:135], v[48:63]
    ds_read_b64_tr_b16 v[92:93], v13 offset:6144
    ds_read_b64_tr_b16 v[94:95], v13 offset:7168
    ds_read_b32 v6, v254
    s_waitcnt lgkmcnt(5)
    v_mfma_f32_32x32x16_bf16 v[32:47], v[80:83], v[136:139], v[32:47]
    ds_read_b64_tr_b16 v[64:65], v12 offset:8192
    ds_read_b64_tr_b16 v[66:67], v12 offset:9216
    buffer_load_dwordx4 v[184:187], v1, s[12:15], s50 offen offset:2048 sc1
    v_mfma_f32_32x32x16_bf16 v[48:63], v[84:87], v[136:139], v[48:63]
    ds_read_b64_tr_b16 v[68:69], v13 offset:8192
    ds_read_b64_tr_b16 v[70:71], v13 offset:9216
    s_waitcnt lgkmcnt(5)
    v_mfma_f32_32x32x16_bf16 v[32:47], v[88:91], v[140:143], v[32:47]
    ds_read_b64_tr_b16 v[72:73], v12 offset:10240
    ds_read_b64_tr_b16 v[74:75], v12 offset:11264
    buffer_load_dwordx4 v[188:191], v1, s[12:15], s50 offen offset:3072 sc1
    v_mfma_f32_32x32x16_bf16 v[48:63], v[92:95], v[140:143], v[48:63]
    ds_read_b64_tr_b16 v[76:77], v13 offset:10240
    ds_read_b64_tr_b16 v[78:79], v13 offset:11264
    s_waitcnt vmcnt(8)
    s_bfe_u32 s50, s61, 0x40018
    s_lshl_b32 s51, s50, 1
    s_lshl_b32 s51, 3, s51
    s_and_b32 s101, s56, s51
    s_cmp_eq_u32 s101, s51
    s_cbranch_scc0 L_ypw_30
L_ypwd_30:
    s_lshl_b32 s50, s50, 12
    s_add_u32 s50, s50, s39
    s_waitcnt lgkmcnt(4)
    v_cmp_gt_u32 vcc, s48, v6
    s_cbranch_vccnz L_yps_27
L_ypsd_27:
    ds_add_u32 v254, v255
    s_add_u32 s48, s48, 4
    v_mfma_f32_32x32x16_bf16 v[32:47], v[64:67], v[144:147], v[32:47]
    ds_read_b64_tr_b16 v[80:81], v12 offset:12288
    ds_read_b64_tr_b16 v[82:83], v12 offset:13312
    buffer_load_dwordx4 v[192:195], v1, s[12:15], s50 offen offset:0 sc1
    v_mfma_f32_32x32x16_bf16 v[48:63], v[68:71], v[144:147], v[48:63]
    ds_read_b64_tr_b16 v[84:85], v13 offset:12288
    ds_read_b64_tr_b16 v[86:87], v13 offset:13312
    s_waitcnt lgkmcnt(5)
    v_mfma_f32_32x32x16_bf16 v[32:47], v[72:75], v[148:151], v[32:47]
    ds_read_b64_tr_b16 v[88:89], v12 offset:14336
    ds_read_b64_tr_b16 v[90:91], v12 offset:15360
    buffer_load_dwordx4 v[196:199], v1, s[12:15], s50 offen offset:1024 sc1
    v_mfma_f32_32x32x16_bf16 v[48:63], v[76:79], v[148:151], v[48:63]
    ds_read_b64_tr_b16 v[92:93], v13 offset:14336
    ds_read_b64_tr_b16 v[94:95], v13 offset:15360
    s_waitcnt lgkmcnt(4)
    v_mfma_f32_32x32x16_bf16 v[32:47], v[80:83], v[152:155], v[32:47]
    ds_read_b64_tr_b16 v[64:65], v12 offset:16384
    ds_read_b64_tr_b16 v[66:67], v12 offset:17408
    buffer_load_dwordx4 v[200:203], v1, s[12:15], s50 offen offset:2048 sc1
    v_mfma_f32_32x32x16_bf16 v[48:63], v[84:87], v[152:155], v[48:63]
    ds_read_b64_tr_b16 v[68:69], v13 offset:16384
    ds_read_b64_tr_b16 v[70:71], v13 offset:17408
    s_waitcnt lgkmcnt(4)
    v_mfma_f32_32x32x16_bf16 v[32:47], v[88:91], v[156:159], v[32:47]
    ds_read_b64_tr_b16 v[72:73], v12 offset:18432
    ds_read_b64_tr_b16 v[74:75], v12 offset:19456
    buffer_load_dwordx4 v[204:207], v1, s[12:15], s50 offen offset:3072 sc1
    v_mfma_f32_32x32x16_bf16 v[48:63], v[92:95], v[156:159], v[48:63]
    ds_read_b64_tr_b16 v[76:77], v13 offset:18432
    ds_read_b64_tr_b16 v[78:79], v13 offset:19456
    s_waitcnt vmcnt(8)
    s_bfe_u32 s50, s61, 0x4001c
    s_lshl_b32 s51, s50, 1
    s_lshl_b32 s51, 3, s51
    s_and_b32 s101, s56, s51
    s_cmp_eq_u32 s101, s51
    s_cbranch_scc0 L_ypw_31
L_ypwd_31:
    s_lshl_b32 s50, s50, 12
    s_add_u32 s50, s50, s39
    s_waitcnt lgkmcnt(4)
    v_mfma_f32_32x32x16_bf16 v[32:47], v[64:67], v[160:163], v[32:47]
    ds_read_b64_tr_b16 v[80:81], v12 offset:20480
    ds_read_b64_tr_b16 v[82:83], v12 offset:21504
    buffer_load_dwordx4 v[208:211], v1, s[12:15], s50 offen offset:0 sc1
    v_mfma_f32_32x32x16_bf16 v[48:63], v[68:71], v[160:163], v[48:63]
    ds_read_b64_tr_b16 v[84:85], v13 offset:20480
    ds_read_b64_tr_b16 v[86:87], v13 offset:21504
    s_waitcnt lgkmcnt(4)
    v_mfma_f32_32x32x16_bf16 v[32:47], v[72:75], v[164:167], v[32:47]
    ds_read_b64_tr_b16 v[88:89], v12 offset:22528
    ds_read_b64_tr_b16 v[90:91], v12 offset:23552
    buffer_load_dwordx4 v[212:215], v1, s[12:15], s50 offen offset:1024 sc1
    v_mfma_f32_32x32x16_bf16 v[48:63], v[76:79], v[164:167], v[48:63]
    ds_read_b64_tr_b16 v[92:93], v13 offset:22528
    ds_read_b64_tr_b16 v[94:95], v13 offset:23552
    ds_read_b32 v6, v254
    s_waitcnt lgkmcnt(5)
    v_mfma_f32_32x32x16_bf16 v[32:47], v[80:83], v[168:171], v[32:47]
    ds_read_b64_tr_b16 v[64:65], v12 offset:24576
    ds_read_b64_tr_b16 v[66:67], v12 offset:25600
    buffer_load_dwordx4 v[216:219], v1, s[12:15], s50 offen offset:2048 sc1
    v_mfma_f32_32x32x16_bf16 v[48:63], v[84:87], v[168:171], v[48:63]
    ds_read_b64_tr_b16 v[68:69], v13 offset:24576
    ds_read_b64_tr_b16 v[70:71], v13 offset:25600
    s_waitcnt lgkmcnt(5)
    v_mfma_f32_32x32x16_bf16 v[32:47], v[88:91], v[172:175], v[32:47]
    ds_read_b64_tr_b16 v[72:73], v12 offset:26624
    ds_read_b64_tr_b16 v[74:75], v12 offset:27648
    buffer_load_dwordx4 v[220:223], v1, s[12:15], s50 offen offset:3072 sc1
    v_mfma_f32_32x32x16_bf16 v[48:63], v[92:95], v[172:175], v[48:63]
    ds_read_b64_tr_b16 v[76:77], v13 offset:26624
    ds_read_b64_tr_b16 v[78:79], v13 offset:27648
    s_waitcnt vmcnt(8)
    s_waitcnt lgkmcnt(4)
    v_mfma_f32_32x32x16_bf16 v[32:47], v[64:67], v[176:179], v[32:47]
    ds_read_b64_tr_b16 v[80:81], v12 offset:28672
    ds_read_b64_tr_b16 v[82:83], v12 offset:29696
    v_mfma_f32_32x32x16_bf16 v[48:63], v[68:71], v[176:179], v[48:63]
    ds_read_b64_tr_b16 v[84:85], v13 offset:28672
    ds_read_b64_tr_b16 v[86:87], v13 offset:29696
    s_waitcnt lgkmcnt(4)
    v_mfma_f32_32x32x16_bf16 v[32:47], v[72:75], v[180:183], v[32:47]
    ds_read_b64_tr_b16 v[88:89], v12 offset:30720
    ds_read_b64_tr_b16 v[90:91], v12 offset:31744
    v_mfma_f32_32x32x16_bf16 v[48:63], v[76:79], v[180:183], v[48:63]
    ds_read_b64_tr_b16 v[92:93], v13 offset:30720
    ds_read_b64_tr_b16 v[94:95], v13 offset:31744
    s_waitcnt lgkmcnt(4)
    v_mfma_f32_32x32x16_bf16 v[32:47], v[80:83], v[184:187], v[32:47]
    ds_read_b64_tr_b16 v[64:65], v12 offset:32768
    ds_read_b64_tr_b16 v[66:67], v12 offset:33792
    v_mfma_f32_32x32x16_bf16 v[48:63], v[84:87], v[184:187], v[48:63]
    ds_read_b64_tr_b16 v[68:69], v13 offset:32768
    ds_read_b64_tr_b16 v[70:71], v13 offset:33792
    s_waitcnt lgkmcnt(4)
    v_mfma_f32_32x32x16_bf16 v[32:47], v[88:91], v[188:191], v[32:47]
    ds_read_b64_tr_b16 v[72:73], v12 offset:34816
    ds_read_b64_tr_b16 v[74:75], v12 offset:35840
    v_mfma_f32_32x32x16_bf16 v[48:63], v[92:95], v[188:191], v[48:63]
    ds_read_b64_tr_b16 v[76:77], v13 offset:34816
    ds_read_b64_tr_b16 v[78:79], v13 offset:35840
    s_waitcnt vmcnt(4)
    s_waitcnt lgkmcnt(4)
    v_mfma_f32_32x32x16_bf16 v[32:47], v[64:67], v[192:195], v[32:47]
    ds_read_b64_tr_b16 v[80:81], v12 offset:36864
    ds_read_b64_tr_b16 v[82:83], v12 offset:37888
    v_mfma_f32_32x32x16_bf16 v[48:63], v[68:71], v[192:195], v[48:63]
    ds_read_b64_tr_b16 v[84:85], v13 offset:36864
    ds_read_b64_tr_b16 v[86:87], v13 offset:37888
    s_waitcnt lgkmcnt(4)
    v_mfma_f32_32x32x16_bf16 v[32:47], v[72:75], v[196:199], v[32:47]
    ds_read_b64_tr_b16 v[88:89], v12 offset:38912
    ds_read_b64_tr_b16 v[90:91], v12 offset:39936
    v_mfma_f32_32x32x16_bf16 v[48:63], v[76:79], v[196:199], v[48:63]
    ds_read_b64_tr_b16 v[92:93], v13 offset:38912
    ds_read_b64_tr_b16 v[94:95], v13 offset:39936
    ds_read_b32 v6, v254
    s_waitcnt lgkmcnt(5)
    v_mfma_f32_32x32x16_bf16 v[32:47], v[80:83], v[200:203], v[32:47]
    ds_read_b64_tr_b16 v[64:65], v12 offset:40960
    ds_read_b64_tr_b16 v[66:67], v12 offset:41984
    v_mfma_f32_32x32x16_bf16 v[48:63], v[84:87], v[200:203], v[48:63]
    ds_read_b64_tr_b16 v[68:69], v13 offset:40960
    ds_read_b64_tr_b16 v[70:71], v13 offset:41984
    s_waitcnt lgkmcnt(5)
    v_mfma_f32_32x32x16_bf16 v[32:47], v[88:91], v[204:207], v[32:47]
    ds_read_b64_tr_b16 v[72:73], v12 offset:43008
    ds_read_b64_tr_b16 v[74:75], v12 offset:44032
    v_mfma_f32_32x32x16_bf16 v[48:63], v[92:95], v[204:207], v[48:63]
    ds_read_b64_tr_b16 v[76:77], v13 offset:43008
    ds_read_b64_tr_b16 v[78:79], v13 offset:44032
    s_waitcnt vmcnt(0)
    s_waitcnt lgkmcnt(4)
    v_mfma_f32_32x32x16_bf16 v[32:47], v[64:67], v[208:211], v[32:47]
    ds_read_b64_tr_b16 v[80:81], v12 offset:45056
    ds_read_b64_tr_b16 v[82:83], v12 offset:46080
    v_mfma_f32_32x32x16_bf16 v[48:63], v[68:71], v[208:211], v[48:63]
    ds_read_b64_tr_b16 v[84:85], v13 offset:45056
    ds_read_b64_tr_b16 v[86:87], v13 offset:46080
    s_waitcnt lgkmcnt(4)
    v_mfma_f32_32x32x16_bf16 v[32:47], v[72:75], v[212:215], v[32:47]
    ds_read_b64_tr_b16 v[88:89], v12 offset:47104
    ds_read_b64_tr_b16 v[90:91], v12 offset:48128
    v_mfma_f32_32x32x16_bf16 v[48:63], v[76:79], v[212:215], v[48:63]
    ds_read_b64_tr_b16 v[92:93], v13 offset:47104
    ds_read_b64_tr_b16 v[94:95], v13 offset:48128
    s_waitcnt lgkmcnt(4)
    v_mfma_f32_32x32x16_bf16 v[32:47], v[80:83], v[216:219], v[32:47]
    v_mfma_f32_32x32x16_bf16 v[48:63], v[84:87], v[216:219], v[48:63]
    s_waitcnt lgkmcnt(0)
    v_mfma_f32_32x32x16_bf16 v[32:47], v[88:91], v[220:223], v[32:47]
    v_mfma_f32_32x32x16_bf16 v[48:63], v[92:95], v[220:223], v[48:63]
    s_mov_b32 s50, s58
    s_nop 9
    v_cvt_pk_bf16_f32 v32, v32, v33
    v_cvt_pk_bf16_f32 v33, v34, v35
    v_cvt_pk_bf16_f32 v34, v36, v37
    v_cvt_pk_bf16_f32 v35, v38, v39
    v_cvt_pk_bf16_f32 v36, v40, v41
    v_cvt_pk_bf16_f32 v37, v42, v43
    v_cvt_pk_bf16_f32 v38, v44, v45
    v_cvt_pk_bf16_f32 v39, v46, v47
    ds_write_b128 v16, v[32:35]
    ds_write_b128 v17, v[36:39]
    v_cvt_pk_bf16_f32 v48, v48, v49
    v_cvt_pk_bf16_f32 v49, v50, v51
    v_cvt_pk_bf16_f32 v50, v52, v53
    v_cvt_pk_bf16_f32 v51, v54, v55
    v_cvt_pk_bf16_f32 v52, v56, v57
    v_cvt_pk_bf16_f32 v53, v58, v59
    v_cvt_pk_bf16_f32 v54, v60, v61
    v_cvt_pk_bf16_f32 v55, v62, v63
    ds_write_b128 v18, v[48:51]
    ds_write_b128 v19, v[52:55]
    ds_read_b128 v[64:67], v20 offset:0
    ds_read_b128 v[68:71], v20 offset:1024
    ds_read_b128 v[72:75], v20 offset:2048
    ds_read_b128 v[76:79], v20 offset:3072
    s_waitcnt lgkmcnt(3)
    buffer_store_dwordx4 v[64:67], v11, s[8:11], s50 offen sc1
    s_add_u32 s50, s50, 0x8000
    s_waitcnt lgkmcnt(2)
    buffer_store_dwordx4 v[68:71], v11, s[8:11], s50 offen sc1
    s_add_u32 s50, s50, 0x8000
    s_waitcnt lgkmcnt(1)
    buffer_store_dwordx4 v[72:75], v11, s[8:11], s50 offen sc1
    s_add_u32 s50, s50, 0x8000
    s_waitcnt lgkmcnt(0)
    buffer_store_dwordx4 v[76:79], v11, s[8:11], s50 offen sc1
    s_add_u32 s50, s50, 0x8000
    s_endpgm
L_x:
    s_getpc_b64 s[4:5]
L_pc0:
    s_sub_u32 s4, s4, L_pc0-fused_kernel
    s_subb_u32 s5, s5, 0
    s_mov_b32 s6, L_code_end-fused_kernel
    s_mov_b32 s7, 0x00020000
    s_and_b32 s44, s31, 1
    s_lshl_b32 s44, s44, 2
    s_add_u32 s44, s44, s16
    s_lshl_b32 s44, s44, 13
    v_lshlrev_b32 v242, 7, v0
    buffer_load_dword v242, v242, s[4:7], s44 offen
    v_lshlrev_b32 v254, 2, v0
    v_add_u32 v254, 162816, v254
    v_mov_b32 v2, 0
    ds_write_b32 v254, v2
    ds_write_b32 v254, v2 offset:256
    ds_write_b32 v254, v2 offset:512
    s_and_b32 s50, s59, 1
    s_lshl_b32 s50, s50, 8
    v_add_u32 v254, s50, v254
    s_waitcnt lgkmcnt(0)
    s_mov_b32 s12, s28
    s_mov_b32 s13, s29
    s_mov_b32 s14, 0x2200000
    s_mov_b32 s15, 0x00020000
    s_or_b32 s50, s2, s16
    s_cmp_lg_u32 s50, 0
    s_cbranch_scc1 L_x_noent
    v_mov_b32 v8, 1048576
    s_mov_b64 exec, 1
    buffer_load_dwordx2 v[12:13], v8, s[12:15], 0 offen sc1
    v_mov_b32 v14, 1
    v_mov_b32 v15, 1
    v_mov_b32 v9, 0
    s_waitcnt vmcnt(0)
    v_add_u32 v12, 1, v12
    buffer_store_dwordx2 v[12:13], v8, s[12:15], 0 offen sc1
    s_waitcnt vmcnt(0)
    global_store_dwordx4 v9, v[12:15], s[18:19] sc1
    s_mov_b64 exec, -1
L_x_noent:
    s_and_b32 s35, s33, 7
    s_lshl_b32 s35, s35, 1
    s_lshr_b32 s50, s33, 3
    s_or_b32 s35, s35, s50
    s_lshl_b32 s49, s34, 2
    s_add_u32 s49, s49, s59
    s_lshl_b32 s49, s49, 11
    s_add_u32 s49, s49, 131072
    s_lshl_b32 s32, s35, 7
    s_add_u32 s32, s32, s49
    v_mov_b32 v243, s32
    buffer_load_dword v243, v243, s[12:15], 0 offen
    s_lshl_b32 s49, s34, 2
    s_add_u32 s49, s49, s59
    s_lshl_b32 s49, s49, 11
    s_add_u32 s49, s49, 0
    s_lshl_b32 s32, s33, 7
    s_add_u32 s32, s32, s49
    v_mov_b32 v244, s32
    buffer_load_dword v244, v244, s[12:15], 0 offen
    s_lshr_b32 s36, s59, 1
    s_and_b32 s37, s59, 1
    v_and_b32 v6, 15, v0
    v_lshrrev_b32 v8, 4, v0
    v_bfe_u32 v5, v0, 1, 3
    v_lshlrev_b32 v6, 7, v6
    s_lshl_b32 s38, s36, 13
    s_add_u32 s38, s38, 0
    v_add_u32 v6, s38, v6
    v_xor_b32 v1, v8, v5
    v_xor_b32 v2, 4, v1
    v_lshl_add_u32 v1, v1, 4, v6
    v_lshl_add_u32 v2, v2, 4, v6
    v_lshrrev_b32 v6, 5, v0
    s_mov_b32 s39, 6144
    v_mul_lo_u32 v6, v6, s39
    v_and_b32 v8, 1, v8
    v_bfe_u32 v5, v0, 2, 2
    v_lshl_add_u32 v5, v8, 3, v5
    v_lshl_add_u32 v6, v5, 7, v6
    v_and_b32 v5, 3, v0
    v_lshl_add_u32 v6, v5, 3, v6
    v_add_u32 v6, 16384, v6
    v_bfe_u32 v5, v0, 3, 1
    v_lshl_or_b32 v5, v8, 1, v5
    s_lshl_b32 s38, s37, 1
    v_xor_b32 v5, s38, v5
    v_lshl_add_u32 v3, v5, 5, v6
    v_xor_b32 v5, 1, v5
    v_lshl_add_u32 v4, v5, 5, v6
    s_lshl_b32 s44, s34, 1
    s_add_u32 s44, s44, s37
    s_lshl_b32 s44, s44, 6
    s_lshl_b32 s45, s35, 2
    s_add_u32 s44, s44, s45
    s_lshl_b32 s45, s36, 1
    s_add_u32 s44, s44, s45
    s_lshl_b32 s65, s44, 12
    s_add_u32 s65, s65, 16777216
    s_mov_b32 s67, 0x3e8293ee
    v_and_b32 v5, 15, v0
    v_lshrrev_b32 v6, 4, v0
    v_lshlrev_b32 v5, 4, v5
    v_lshl_add_u32 v5, v6, 9, v5
    s_mov_b32 s17, 0
    s_mov_b32 s48, 0
    v_mov_b32 v64, 0
    v_mov_b32 v65, 0
    v_mov_b32 v66, 0
    v_mov_b32 v67, 0
    v_mov_b32 v68, 0
    v_mov_b32 v69, 0
    v_mov_b32 v70, 0
    v_mov_b32 v71, 0
    v_mov_b32 v72, 0
    v_mov_b32 v73, 0
    v_mov_b32 v74, 0
    v_mov_b32 v75, 0
    v_mov_b32 v76, 0
    v_mov_b32 v77, 0
    v_mov_b32 v78, 0
    v_mov_b32 v79, 0
    v_mov_b32 v80, 0
    v_mov_b32 v81, 0
    v_mov_b32 v82, 0
    v_mov_b32 v83, 0
    v_mov_b32 v84, 0
    v_mov_b32 v85, 0
    v_mov_b32 v86, 0
    v_mov_b32 v87, 0
    v_mov_b32 v88, 0
    v_mov_b32 v89, 0
    v_mov_b32 v90, 0
    v_mov_b32 v91, 0
    v_mov_b32 v92, 0
    v_mov_b32 v93, 0
    v_mov_b32 v94, 0
    v_mov_b32 v95, 0
    v_mov_b32 v96, 0
    v_mov_b32 v97, 0
    v_mov_b32 v98, 0
    v_mov_b32 v99, 0
    v_mov_b32 v100, 0
    v_mov_b32 v101, 0
    v_mov_b32 v102, 0
    v_mov_b32 v103, 0
    v_mov_b32 v104, 0
    v_mov_b32 v105, 0
    v_mov_b32 v106, 0
    v_mov_b32 v107, 0
    v_mov_b32 v108, 0
    v_mov_b32 v109, 0
    v_mov_b32 v110, 0
    v_mov_b32 v111, 0
    v_mov_b32 v112, 0
    v_mov_b32 v113, 0
    v_mov_b32 v114, 0
    v_mov_b32 v115, 0
    v_mov_b32 v116, 0
    v_mov_b32 v117, 0
    v_mov_b32 v118, 0
    v_mov_b32 v119, 0
    v_mov_b32 v120, 0
    v_mov_b32 v121, 0
    v_mov_b32 v122, 0
    v_mov_b32 v123, 0
    v_mov_b32 v124, 0
    v_mov_b32 v125, 0
    v_mov_b32 v126, 0
    v_mov_b32 v127, 0
    v_mov_b32 v128, 0
    v_mov_b32 v129, 0
    v_mov_b32 v130, 0
    v_mov_b32 v131, 0
    v_mov_b32 v132, 0
    v_mov_b32 v133, 0
    v_mov_b32 v134, 0
    v_mov_b32 v135, 0
    v_mov_b32 v136, 0
    v_mov_b32 v137, 0
    v_mov_b32 v138, 0
    v_mov_b32 v139, 0
    v_mov_b32 v140, 0
    v_mov_b32 v141, 0
    v_mov_b32 v142, 0
    v_mov_b32 v143, 0
    v_mov_b32 v144, 0
    v_mov_b32 v145, 0
    v_mov_b32 v146, 0
    v_mov_b32 v147, 0
    v_mov_b32 v148, 0
    v_mov_b32 v149, 0
    v_mov_b32 v150, 0
    v_mov_b32 v151, 0
    v_mov_b32 v152, 0
    v_mov_b32 v153, 0
    v_mov_b32 v154, 0
    v_mov_b32 v155, 0
    v_mov_b32 v156, 0
    v_mov_b32 v157, 0
    v_mov_b32 v158, 0
    v_mov_b32 v159, 0
    s_lshl_b32 s49, s33, 1
    s_add_u32 s49, s49, s36
    s_lshl_b32 s49, s49, 12
    s_add_u32 s49, s49, 262144
    s_lshl_b32 s32, s34, 1
    s_add_u32 s32, s32, s37
    s_lshl_b32 s32, s32, 7
    s_add_u32 s32, s32, s49
    v_mov_b32 v245, s32
    buffer_load_dword v245, v245, s[12:15], 0 offen
    s_lshl_b32 s49, s33, 1
    s_add_u32 s49, s49, s36
    s_lshl_b32 s49, s49, 12
    s_add_u32 s49, s49, 393216
    s_lshl_b32 s32, s34, 1
    s_add_u32 s32, s32, s37
    s_lshl_b32 s32, s32, 7
    s_add_u32 s32, s32, s49
    v_mov_b32 v246, s32
    buffer_load_dword v246, v246, s[12:15], 0 offen
    s_mov_b32 s31, 40960
    s_mov_b32 s45, 0
    s_barrier
    ds_read_b128 v[8:11], v1 offset:0
    ds_read_b128 v[12:15], v1 offset:2048
    ds_read_b128 v[16:19], v1 offset:4096
    ds_read_b128 v[20:23], v1 offset:6144
    ds_read_b64_tr_b16 v[40:41], v3 offset:0
    ds_read_b64_tr_b16 v[42:43], v3 offset:512
    ds_read_b64_tr_b16 v[44:45], v4 offset:0
    ds_read_b64_tr_b16 v[46:47], v4 offset:512
    ds_read_b64_tr_b16 v[48:49], v3 offset:2048
    ds_read_b64_tr_b16 v[50:51], v3 offset:2560
    ds_read_b64_tr_b16 v[52:53], v4 offset:2048
    ds_read_b64_tr_b16 v[54:55], v4 offset:2560
    ds_read_b64_tr_b16 v[56:57], v3 offset:4096
    ds_read_b64_tr_b16 v[58:59], v3 offset:4608
    ds_read_b64_tr_b16 v[60:61], v4 offset:4096
    ds_read_b64_tr_b16 v[62:63], v4 offset:4608
    s_waitcnt lgkmcnt(0)
.p2align 6
L_x_loopB:
    v_mfma_f32_16x16x32_bf16 v[64:67], v[40:43], v[8:11], v[64:67]
    s_waitcnt lgkmcnt(11)
    ds_read_b64_tr_b16 v[62:63], v4 offset:4608
    v_mfma_f32_16x16x32_bf16 v[80:83], v[40:43], v[12:15], v[80:83]
    s_waitcnt lgkmcnt(11)
    ds_read_b128 v[24:27], v2 offset:0
    v_mfma_f32_16x16x32_bf16 v[96:99], v[40:43], v[16:19], v[96:99]
    s_waitcnt lgkmcnt(11)
    v_mfma_f32_16x16x32_bf16 v[112:115], v[40:43], v[20:23], v[112:115]
    s_waitcnt lgkmcnt(9)
    ds_read_b64_tr_b16 v[40:41], v3 offset:12288
    v_mfma_f32_16x16x32_bf16 v[68:71], v[44:47], v[8:11], v[68:71]
    ds_read_b64_tr_b16 v[42:43], v3 offset:12800
    v_mfma_f32_16x16x32_bf16 v[84:87], v[44:47], v[12:15], v[84:87]
    ds_read_b128 v[28:31], v2 offset:2048
    v_mfma_f32_16x16x32_bf16 v[100:103], v[44:47], v[16:19], v[100:103]
    v_mfma_f32_16x16x32_bf16 v[116:119], v[44:47], v[20:23], v[116:119]
    s_waitcnt lgkmcnt(10)
    ds_read_b64_tr_b16 v[44:45], v4 offset:12288
    v_mfma_f32_16x16x32_bf16 v[72:75], v[48:51], v[8:11], v[72:75]
    ds_read_b64_tr_b16 v[46:47], v4 offset:12800
    v_mfma_f32_16x16x32_bf16 v[88:91], v[48:51], v[12:15], v[88:91]
    ds_read_b128 v[32:35], v2 offset:4096
    v_mfma_f32_16x16x32_bf16 v[104:107], v[48:51], v[16:19], v[104:107]
    v_mfma_f32_16x16x32_bf16 v[120:123], v[48:51], v[20:23], v[120:123]
    s_waitcnt lgkmcnt(11)
    ds_read_b64_tr_b16 v[48:49], v3 offset:14336
    v_mfma_f32_16x16x32_bf16 v[76:79], v[52:55], v[8:11], v[76:79]
    ds_read_b64_tr_b16 v[50:51], v3 offset:14848
    v_mfma_f32_16x16x32_bf16 v[92:95], v[52:55], v[12:15], v[92:95]
    ds_read_b128 v[36:39], v2 offset:6144
    v_mfma_f32_16x16x32_bf16 v[108:111], v[52:55], v[16:19], v[108:111]
    v_mfma_f32_16x16x32_bf16 v[124:127], v[52:55], v[20:23], v[124:127]
    s_waitcnt lgkmcnt(12)
    ds_read_b64_tr_b16 v[52:53], v4 offset:14336
    v_mfma_f32_16x16x32_bf16 v[128:131], v[8:11], v[56:59], v[128:131]
    ds_read_b64_tr_b16 v[54:55], v4 offset:14848
    v_mfma_f32_16x16x32_bf16 v[132:135], v[12:15], v[56:59], v[132:135]
    v_mfma_f32_16x16x32_bf16 v[144:147], v[16:19], v[56:59], v[144:147]
    v_mfma_f32_16x16x32_bf16 v[148:151], v[20:23], v[56:59], v[148:151]
    s_waitcnt lgkmcnt(12)
    ds_read_b64_tr_b16 v[56:57], v3 offset:16384
    v_mfma_f32_16x16x32_bf16 v[136:139], v[8:11], v[60:63], v[136:139]
    ds_read_b64_tr_b16 v[58:59], v3 offset:16896
    v_mfma_f32_16x16x32_bf16 v[140:143], v[12:15], v[60:63], v[140:143]
    v_mfma_f32_16x16x32_bf16 v[152:155], v[16:19], v[60:63], v[152:155]
    v_mfma_f32_16x16x32_bf16 v[156:159], v[20:23], v[60:63], v[156:159]
    s_waitcnt lgkmcnt(11)
    ds_read_b64_tr_b16 v[60:61], v4 offset:16384
    v_mfma_f32_16x16x32_bf16 v[64:67], v[40:43], v[24:27], v[64:67]
    s_waitcnt lgkmcnt(11)
    ds_read_b64_tr_b16 v[62:63], v4 offset:16896
    v_mfma_f32_16x16x32_bf16 v[80:83], v[40:43], v[28:31], v[80:83]
    s_waitcnt lgkmcnt(9)
    s_add_u32 s17, s17, 1
    s_add_u32 s45, s45, 1
    v_mfma_f32_16x16x32_bf16 v[96:99], v[40:43], v[32:35], v[96:99]
    s_waitcnt lgkmcnt(6)
    s_cmp_eq_u32 s45, 3
    s_cselect_b32 s3, 0xfffec000, s31
    v_mfma_f32_16x16x32_bf16 v[112:115], v[40:43], v[36:39], v[112:115]
    s_cselect_b32 s45, 0, s45
    v_add_u32 v3, s3, v3
    v_mfma_f32_16x16x32_bf16 v[68:71], v[44:47], v[24:27], v[68:71]
    v_add_u32 v1, s3, v1
    v_add_u32 v4, s3, v4
    v_mfma_f32_16x16x32_bf16 v[84:87], v[44:47], v[28:31], v[84:87]
    v_add_u32 v2, s3, v2
    v_mfma_f32_16x16x32_bf16 v[100:103], v[44:47], v[32:35], v[100:103]
    v_mfma_f32_16x16x32_bf16 v[116:119], v[44:47], v[36:39], v[116:119]
    s_waitcnt lgkmcnt(0)
    v_mfma_f32_16x16x32_bf16 v[72:75], v[48:51], v[24:27], v[72:75]
    s_barrier
    v_mfma_f32_16x16x32_bf16 v[88:91], v[48:51], v[28:31], v[88:91]
    ds_read_b64_tr_b16 v[40:41], v3 offset:0
    v_mfma_f32_16x16x32_bf16 v[104:107], v[48:51], v[32:35], v[104:107]
    ds_read_b64_tr_b16 v[42:43], v3 offset:512
    v_mfma_f32_16x16x32_bf16 v[120:123], v[48:51], v[36:39], v[120:123]
    ds_read_b128 v[8:11], v1 offset:0
    v_mfma_f32_16x16x32_bf16 v[76:79], v[52:55], v[24:27], v[76:79]
    ds_read_b128 v[12:15], v1 offset:2048
    v_mfma_f32_16x16x32_bf16 v[92:95], v[52:55], v[28:31], v[92:95]
    ds_read_b128 v[16:19], v1 offset:4096
    v_mfma_f32_16x16x32_bf16 v[108:111], v[52:55], v[32:35], v[108:111]
    ds_read_b128 v[20:23], v1 offset:6144
    v_mfma_f32_16x16x32_bf16 v[124:127], v[52:55], v[36:39], v[124:127]
    ds_read_b64_tr_b16 v[44:45], v4 offset:0
    v_mfma_f32_16x16x32_bf16 v[128:131], v[24:27], v[56:59], v[128:131]
    ds_read_b64_tr_b16 v[46:47], v4 offset:512
    v_mfma_f32_16x16x32_bf16 v[132:135], v[28:31], v[56:59], v[132:135]
    ds_read_b64_tr_b16 v[48:49], v3 offset:2048
    v_mfma_f32_16x16x32_bf16 v[144:147], v[32:35], v[56:59], v[144:147]
    ds_read_b64_tr_b16 v[50:51], v3 offset:2560
    v_mfma_f32_16x16x32_bf16 v[148:151], v[36:39], v[56:59], v[148:151]
    ds_read_b64_tr_b16 v[52:53], v4 offset:2048
    v_mfma_f32_16x16x32_bf16 v[136:139], v[24:27], v[60:63], v[136:139]
    ds_read_b64_tr_b16 v[54:55], v4 offset:2560
    v_mfma_f32_16x16x32_bf16 v[140:143], v[28:31], v[60:63], v[140:143]
    ds_read_b64_tr_b16 v[56:57], v3 offset:4096
    v_mfma_f32_16x16x32_bf16 v[152:155], v[32:35], v[60:63], v[152:155]
    ds_read_b64_tr_b16 v[58:59], v3 offset:4608
    v_mfma_f32_16x16x32_bf16 v[156:159], v[36:39], v[60:63], v[156:159]
    s_waitcnt lgkmcnt(11)
    ds_read_b64_tr_b16 v[60:61], v4 offset:4096
    v_mfma_f32_16x16x32_bf16 v[64:67], v[40:43], v[8:11], v[64:67]
    s_waitcnt lgkmcnt(11)
    ds_read_b64_tr_b16 v[62:63], v4 offset:4608
    v_mfma_f32_16x16x32_bf16 v[80:83], v[40:43], v[12:15], v[80:83]
    s_waitcnt lgkmcnt(11)
    ds_read_b128 v[24:27], v2 offset:0
    v_mfma_f32_16x16x32_bf16 v[96:99], v[40:43], v[16:19], v[96:99]
    s_waitcnt lgkmcnt(11)
    v_mfma_f32_16x16x32_bf16 v[112:115], v[40:43], v[20:23], v[112:115]
    s_waitcnt lgkmcnt(9)
    ds_read_b64_tr_b16 v[40:41], v3 offset:12288
    v_mfma_f32_16x16x32_bf16 v[68:71], v[44:47], v[8:11], v[68:71]
    ds_read_b64_tr_b16 v[42:43], v3 offset:12800
    v_mfma_f32_16x16x32_bf16 v[84:87], v[44:47], v[12:15], v[84:87]
    ds_read_b128 v[28:31], v2 offset:2048
    v_mfma_f32_16x16x32_bf16 v[100:103], v[44:47], v[16:19], v[100:103]
    v_mfma_f32_16x16x32_bf16 v[116:119], v[44:47], v[20:23], v[116:119]
    s_waitcnt lgkmcnt(10)
    ds_read_b64_tr_b16 v[44:45], v4 offset:12288
    v_mfma_f32_16x16x32_bf16 v[72:75], v[48:51], v[8:11], v[72:75]
    ds_read_b64_tr_b16 v[46:47], v4 offset:12800
    v_mfma_f32_16x16x32_bf16 v[88:91], v[48:51], v[12:15], v[88:91]
    ds_read_b128 v[32:35], v2 offset:4096
    v_mfma_f32_16x16x32_bf16 v[104:107], v[48:51], v[16:19], v[104:107]
    v_mfma_f32_16x16x32_bf16 v[120:123], v[48:51], v[20:23], v[120:123]
    s_waitcnt lgkmcnt(11)
    ds_read_b64_tr_b16 v[48:49], v3 offset:14336
    v_mfma_f32_16x16x32_bf16 v[76:79], v[52:55], v[8:11], v[76:79]
    ds_read_b64_tr_b16 v[50:51], v3 offset:14848
    v_mfma_f32_16x16x32_bf16 v[92:95], v[52:55], v[12:15], v[92:95]
    ds_read_b128 v[36:39], v2 offset:6144
    v_mfma_f32_16x16x32_bf16 v[108:111], v[52:55], v[16:19], v[108:111]
    v_mfma_f32_16x16x32_bf16 v[124:127], v[52:55], v[20:23], v[124:127]
    s_waitcnt lgkmcnt(12)
    ds_read_b64_tr_b16 v[52:53], v4 offset:14336
    v_mfma_f32_16x16x32_bf16 v[128:131], v[8:11], v[56:59], v[128:131]
    ds_read_b64_tr_b16 v[54:55], v4 offset:14848
    v_mfma_f32_16x16x32_bf16 v[132:135], v[12:15], v[56:59], v[132:135]
    v_mfma_f32_16x16x32_bf16 v[144:147], v[16:19], v[56:59], v[144:147]
    v_mfma_f32_16x16x32_bf16 v[148:151], v[20:23], v[56:59], v[148:151]
    s_waitcnt lgkmcnt(12)
    ds_read_b64_tr_b16 v[56:57], v3 offset:16384
    v_mfma_f32_16x16x32_bf16 v[136:139], v[8:11], v[60:63], v[136:139]
    ds_read_b64_tr_b16 v[58:59], v3 offset:16896
    v_mfma_f32_16x16x32_bf16 v[140:143], v[12:15], v[60:63], v[140:143]
    v_mfma_f32_16x16x32_bf16 v[152:155], v[16:19], v[60:63], v[152:155]
    v_mfma_f32_16x16x32_bf16 v[156:159], v[20:23], v[60:63], v[156:159]
    s_waitcnt lgkmcnt(11)
    ds_read_b64_tr_b16 v[60:61], v4 offset:16384
    v_mfma_f32_16x16x32_bf16 v[64:67], v[40:43], v[24:27], v[64:67]
    s_waitcnt lgkmcnt(11)
    ds_read_b64_tr_b16 v[62:63], v4 offset:16896
    v_mfma_f32_16x16x32_bf16 v[80:83], v[40:43], v[28:31], v[80:83]
    s_waitcnt lgkmcnt(9)
    s_add_u32 s17, s17, 1
    s_add_u32 s45, s45, 1
    v_mfma_f32_16x16x32_bf16 v[96:99], v[40:43], v[32:35], v[96:99]
    s_waitcnt lgkmcnt(6)
    s_cmp_eq_u32 s45, 3
    s_cselect_b32 s3, 0xfffec000, s31
    v_mfma_f32_16x16x32_bf16 v[112:115], v[40:43], v[36:39], v[112:115]
    s_cselect_b32 s45, 0, s45
    v_add_u32 v3, s3, v3
    v_mfma_f32_16x16x32_bf16 v[68:71], v[44:47], v[24:27], v[68:71]
    v_add_u32 v1, s3, v1
    v_add_u32 v4, s3, v4
    v_mfma_f32_16x16x32_bf16 v[84:87], v[44:47], v[28:31], v[84:87]
    v_add_u32 v2, s3, v2
    v_mfma_f32_16x16x32_bf16 v[100:103], v[44:47], v[32:35], v[100:103]
    s_cmp_lt_u32 s17, 16
    v_mfma_f32_16x16x32_bf16 v[116:119], v[44:47], v[36:39], v[116:119]
    s_waitcnt lgkmcnt(0)
    v_mfma_f32_16x16x32_bf16 v[72:75], v[48:51], v[24:27], v[72:75]
    s_barrier
    v_mfma_f32_16x16x32_bf16 v[88:91], v[48:51], v[28:31], v[88:91]
    ds_read_b64_tr_b16 v[40:41], v3 offset:0
    v_mfma_f32_16x16x32_bf16 v[104:107], v[48:51], v[32:35], v[104:107]
    ds_read_b64_tr_b16 v[42:43], v3 offset:512
    v_mfma_f32_16x16x32_bf16 v[120:123], v[48:51], v[36:39], v[120:123]
    ds_read_b128 v[8:11], v1 offset:0
    v_mfma_f32_16x16x32_bf16 v[76:79], v[52:55], v[24:27], v[76:79]
    ds_read_b128 v[12:15], v1 offset:2048
    v_mfma_f32_16x16x32_bf16 v[92:95], v[52:55], v[28:31], v[92:95]
    ds_read_b128 v[16:19], v1 offset:4096
    v_mfma_f32_16x16x32_bf16 v[108:111], v[52:55], v[32:35], v[108:111]
    ds_read_b128 v[20:23], v1 offset:6144
    v_mfma_f32_16x16x32_bf16 v[124:127], v[52:55], v[36:39], v[124:127]
    ds_read_b64_tr_b16 v[44:45], v4 offset:0
    v_mfma_f32_16x16x32_bf16 v[128:131], v[24:27], v[56:59], v[128:131]
    ds_read_b64_tr_b16 v[46:47], v4 offset:512
    v_mfma_f32_16x16x32_bf16 v[132:135], v[28:31], v[56:59], v[132:135]
    ds_read_b64_tr_b16 v[48:49], v3 offset:2048
    v_mfma_f32_16x16x32_bf16 v[144:147], v[32:35], v[56:59], v[144:147]
    ds_read_b64_tr_b16 v[50:51], v3 offset:2560
    v_mfma_f32_16x16x32_bf16 v[148:151], v[36:39], v[56:59], v[148:151]
    ds_read_b64_tr_b16 v[52:53], v4 offset:2048
    v_mfma_f32_16x16x32_bf16 v[136:139], v[24:27], v[60:63], v[136:139]
    ds_read_b64_tr_b16 v[54:55], v4 offset:2560
    v_mfma_f32_16x16x32_bf16 v[140:143], v[28:31], v[60:63], v[140:143]
    ds_read_b64_tr_b16 v[56:57], v3 offset:4096
    v_mfma_f32_16x16x32_bf16 v[152:155], v[32:35], v[60:63], v[152:155]
    ds_read_b64_tr_b16 v[58:59], v3 offset:4608
    v_mfma_f32_16x16x32_bf16 v[156:159], v[36:39], v[60:63], v[156:159]
    s_waitcnt lgkmcnt(11)
    ds_read_b64_tr_b16 v[60:61], v4 offset:4096
    s_cbranch_scc1 L_x_loopB
    s_setprio 3
    s_load_dwordx4 s[68:71], s[18:19], 0
    s_mul_i32 s43, s37, 19456
    s_add_u32 s43, s43, 122880
    s_lshl_b32 s39, s36, 12
    s_add_u32 s40, s43, s39
    s_add_u32 s41, s40, 8192
    s_xor_b32 s39, s39, 4096
    s_add_u32 s39, s43, s39
    s_waitcnt lgkmcnt(0)
    v_lshlrev_b32 v1, 4, v0
    v_add_u32 v8, s40, v5
    v_add_u32 v9, s41, v5
    v_and_b32 v10, 3, v0
    v_bfe_u32 v11, v0, 2, 2
    v_lshl_add_u32 v10, v11, 3, v10
    v_lshrrev_b32 v11, 4, v0
    v_lshlrev_b32 v10, 4, v10
    v_lshl_add_u32 v10, v11, 9, v10
    v_add_u32 v10, s41, v10
    v_add_u32 v11, s41, v1
    v_cvt_pk_bf16_f32 v72, v72, v73
    v_cvt_pk_bf16_f32 v73, v74, v75
    v_cvt_pk_bf16_f32 v74, v76, v77
    v_cvt_pk_bf16_f32 v75, v78, v79
    ds_write_b128 v10, v[72:75] offset:0
    v_cvt_pk_bf16_f32 v88, v88, v89
    v_cvt_pk_bf16_f32 v89, v90, v91
    v_cvt_pk_bf16_f32 v90, v92, v93
    v_cvt_pk_bf16_f32 v91, v94, v95
    ds_write_b128 v10, v[88:91] offset:64
    v_cvt_pk_bf16_f32 v128, v128, v129
    v_cvt_pk_bf16_f32 v129, v130, v131
    v_cvt_pk_bf16_f32 v130, v132, v133
    v_cvt_pk_bf16_f32 v131, v134, v135
    ds_write_b128 v9, v[128:131] offset:2048
    v_cvt_pk_bf16_f32 v136, v136, v137
    v_cvt_pk_bf16_f32 v137, v138, v139
    v_cvt_pk_bf16_f32 v138, v140, v141
    v_cvt_pk_bf16_f32 v139, v142, v143
    ds_write_b128 v9, v[136:139] offset:2304
    ds_read_b128 v[192:195], v11 offset:0
    ds_read_b128 v[196:199], v11 offset:1024
    ds_read_b128 v[200:203], v11 offset:2048
    ds_read_b128 v[204:207], v11 offset:3072
    v_cvt_pk_bf16_f32 v104, v104, v105
    v_cvt_pk_bf16_f32 v105, v106, v107
    v_cvt_pk_bf16_f32 v106, v108, v109
    v_cvt_pk_bf16_f32 v107, v110, v111
    ds_write_b128 v10, v[104:107] offset:0
    v_cvt_pk_bf16_f32 v120, v120, v121
    v_cvt_pk_bf16_f32 v121, v122, v123
    v_cvt_pk_bf16_f32 v122, v124, v125
    v_cvt_pk_bf16_f32 v123, v126, v127
    ds_write_b128 v10, v[120:123] offset:64
    v_cvt_pk_bf16_f32 v144, v144, v145
    v_cvt_pk_bf16_f32 v145, v146, v147
    v_cvt_pk_bf16_f32 v146, v148, v149
    v_cvt_pk_bf16_f32 v147, v150, v151
    ds_write_b128 v9, v[144:147] offset:2048
    v_cvt_pk_bf16_f32 v152, v152, v153
    v_cvt_pk_bf16_f32 v153, v154, v155
    v_cvt_pk_bf16_f32 v154, v156, v157
    v_cvt_pk_bf16_f32 v155, v158, v159
    ds_write_b128 v9, v[152:155] offset:2304
    ds_read_b128 v[208:211], v11 offset:0
    ds_read_b128 v[212:215], v11 offset:1024
    ds_read_b128 v[216:219], v11 offset:2048
    ds_read_b128 v[220:223], v11 offset:3072
    v_mul_f32 v64, s67, v64
    v_mul_f32 v65, s67, v65
    v_mul_f32 v66, s67, v66
    v_mul_f32 v67, s67, v67
    v_mul_f32 v68, s67, v68
    v_mul_f32 v69, s67, v69
    v_mul_f32 v70, s67, v70
    v_mul_f32 v71, s67, v71
    v_cvt_pk_bf16_f32 v64, v64, v65
    v_cvt_pk_bf16_f32 v65, v66, v67
    v_cvt_pk_bf16_f32 v66, v68, v69
    v_cvt_pk_bf16_f32 v67, v70, v71
    ds_write_b128 v8, v[64:67] offset:0
    s_add_u32 s66, s65, 4096
    s_waitcnt lgkmcnt(1)
    buffer_store_dwordx4 v[192:195], v1, s[12:15], s65 offen offset:0 sc1
    buffer_store_dwordx4 v[196:199], v1, s[12:15], s65 offen offset:1024 sc1
    buffer_store_dwordx4 v[200:203], v1, s[12:15], s65 offen offset:2048 sc1
    buffer_store_dwordx4 v[204:207], v1, s[12:15], s65 offen offset:3072 sc1
    buffer_store_dwordx4 v[208:211], v1, s[12:15], s66 offen offset:0 sc1
    buffer_store_dwordx4 v[212:215], v1, s[12:15], s66 offen offset:1024 sc1
    buffer_store_dwordx4 v[216:219], v1, s[12:15], s66 offen offset:2048 sc1
    buffer_store_dwordx4 v[220:223], v1, s[12:15], s66 offen offset:3072 sc1
    v_mul_f32 v80, s67, v80
    v_mul_f32 v81, s67, v81
    v_mul_f32 v82, s67, v82
    v_mul_f32 v83, s67, v83
    v_mul_f32 v84, s67, v84
    v_mul_f32 v85, s67, v85
    v_mul_f32 v86, s67, v86
    v_mul_f32 v87, s67, v87
    v_cvt_pk_bf16_f32 v80, v80, v81
    v_cvt_pk_bf16_f32 v81, v82, v83
    v_cvt_pk_bf16_f32 v82, v84, v85
    v_cvt_pk_bf16_f32 v83, v86, v87
    ds_write_b128 v8, v[80:83] offset:256
    v_mul_f32 v96, s67, v96
    v_mul_f32 v97, s67, v97
    v_mul_f32 v98, s67, v98
    v_mul_f32 v99, s67, v99
    v_mul_f32 v100, s67, v100
    v_mul_f32 v101, s67, v101
    v_mul_f32 v102, s67, v102
    v_mul_f32 v103, s67, v103
    v_cvt_pk_bf16_f32 v96, v96, v97
    v_cvt_pk_bf16_f32 v97, v98, v99
    v_cvt_pk_bf16_f32 v98, v100, v101
    v_cvt_pk_bf16_f32 v99, v102, v103
    ds_write_b128 v8, v[96:99] offset:2048
    v_mul_f32 v112, s67, v112
    v_mul_f32 v113, s67, v113
    v_mul_f32 v114, s67, v114
    v_mul_f32 v115, s67, v115
    v_mul_f32 v116, s67, v116
    v_mul_f32 v117, s67, v117
    v_mul_f32 v118, s67, v118
    v_mul_f32 v119, s67, v119
    v_cvt_pk_bf16_f32 v112, v112, v113
    v_cvt_pk_bf16_f32 v113, v114, v115
    v_cvt_pk_bf16_f32 v114, v116, v117
    v_cvt_pk_bf16_f32 v115, v118, v119
    ds_write_b128 v8, v[112:115] offset:2304
    v_add_u32 v11, s40, v1
    ds_read_b128 v[160:163], v11 offset:0
    ds_read_b128 v[164:167], v11 offset:1024
    ds_read_b128 v[168:171], v11 offset:2048
    ds_read_b128 v[172:175], v11 offset:3072
    ds_add_u32 v254, v255
    s_add_u32 s48, s48, 2
    v_add_u32 v16, s39, v1
    s_mov_b32 s62, s68
    s_mov_b32 s63, s69
    s_cmp_lg_u32 s70, 0
    s_cbranch_scc0 L_non_x
L_nond_x:
    s_lshl_b32 s49, s34, 2
    s_add_u32 s49, s49, s59
    s_lshl_b32 s49, s49, 11
    s_add_u32 s49, s49, 131072
    s_lshl_b32 s32, s35, 7
    s_add_u32 s32, s32, s49
    s_mov_b32 s46, 0x4b800000
    s_mov_b32 s47, 0x42b00000
    v_mov_b32 v4, 0xdddddddd
    v_and_b32 v2, 7, v0
    v_mov_b32 v3, 0x3f803f80
    v_cmp_eq_u32 vcc, 0, v2
    v_mov_b32 v5, 0xff800000
    s_nop 0
    v_cndmask_b32 v8, 0, v3, vcc
    v_cndmask_b32 v9, 0, v3, vcc
    v_cmp_eq_u32 vcc, 4, v2
    s_nop 1
    v_cndmask_b32 v10, 0, v3, vcc
    v_cndmask_b32 v11, 0, v3, vcc
    v_mov_b32 v48, 0
    v_mov_b32 v49, 0
    v_mov_b32 v50, 0
    v_mov_b32 v51, 0
    v_mov_b32 v52, 0
    v_mov_b32 v53, 0
    v_mov_b32 v54, 0
    v_mov_b32 v55, 0
    v_mov_b32 v56, 0
    v_mov_b32 v57, 0
    v_mov_b32 v58, 0
    v_mov_b32 v59, 0
    v_mov_b32 v60, 0
    v_mov_b32 v61, 0
    v_mov_b32 v62, 0
    v_mov_b32 v63, 0
    v_mov_b32 v64, 0
    v_mov_b32 v65, 0
    v_mov_b32 v66, 0
    v_mov_b32 v67, 0
    v_mov_b32 v68, 0
    v_mov_b32 v69, 0
    v_mov_b32 v70, 0
    v_mov_b32 v71, 0
    v_mov_b32 v72, 0
    v_mov_b32 v73, 0
    v_mov_b32 v74, 0
    v_mov_b32 v75, 0
    v_mov_b32 v76, 0
    v_mov_b32 v77, 0
    v_mov_b32 v78, 0
    v_mov_b32 v79, 0
    v_mov_b32 v80, 0
    v_mov_b32 v81, 0
    v_mov_b32 v82, 0
    v_mov_b32 v83, 0
    v_mov_b32 v84, 0
    v_mov_b32 v85, 0
    v_mov_b32 v86, 0
    v_mov_b32 v87, 0
    v_mov_b32 v88, 0
    v_mov_b32 v89, 0
    v_mov_b32 v90, 0
    v_mov_b32 v91, 0
    v_mov_b32 v92, 0
    v_mov_b32 v93, 0
    v_mov_b32 v94, 0
    v_mov_b32 v95, 0
    v_mov_b32 v96, 0
    v_mov_b32 v97, 0
    v_mov_b32 v98, 0
    v_mov_b32 v99, 0
    v_mov_b32 v100, 0
    v_mov_b32 v101, 0
    v_mov_b32 v102, 0
    v_mov_b32 v103, 0
    v_mov_b32 v104, 0
    v_mov_b32 v105, 0
    v_mov_b32 v106, 0
    v_mov_b32 v107, 0
    v_mov_b32 v108, 0
    v_mov_b32 v109, 0
    v_mov_b32 v110, 0
    v_mov_b32 v111, 0
    s_lshl_b32 s50, s35, 14
    s_sub_u32 s38, s65, s50
    s_lshl_b32 s56, 1, s35
    s_lshl_b32 s42, s33, 2
    s_lshl_b32 s50, s36, 1
    s_add_u32 s42, s42, s50
    s_lshl_b32 s42, s42, 5
    s_lshl_b32 s50, s34, 1
    s_add_u32 s42, s42, s50
    s_add_u32 s42, s42, s37
    s_lshl_b32 s42, s42, 11
    s_add_u32 s42, s42, 29360128
    s_mov_b32 s100, 4194304
L_spin_x1:
    ds_read_b32 v6, v254
    s_waitcnt lgkmcnt(0)
    v_cmp_le_u32 vcc, s48, v6
    s_cbranch_vccnz L_spind_x1
    s_sleep 1
    s_sub_u32 s100, s100, 1
    s_cbranch_scc0 L_spin_x1
L_spind_x1:
    ds_read_b128 v[176:179], v16 offset:0
    ds_read_b128 v[180:183], v16 offset:1024
    ds_read_b128 v[184:187], v16 offset:2048
    ds_read_b128 v[188:191], v16 offset:3072
    v_mfma_f32_32x32x16_bf16 v[32:47], v[192:195], v[168:171], 0
    v_mfma_f32_32x32x16_bf16 v[32:47], v[196:199], v[172:175], v[32:47]
    v_mfma_f32_32x32x16_bf16 v[16:31], v[192:195], v[160:163], 0
    v_mfma_f32_32x32x16_bf16 v[16:31], v[196:199], v[164:167], v[16:31]
    s_nop 10
    v_max3_f32 v2, v32, v33, v34
    v_max3_f32 v2, v2, v35, v36
    v_max3_f32 v2, v2, v37, v38
    v_max3_f32 v2, v2, v39, v40
    v_max3_f32 v2, v2, v41, v42
    v_max3_f32 v2, v2, v43, v44
    v_max3_f32 v2, v2, v45, v46
    v_max_f32 v2, v2, v47
    v_mov_b32 v3, v2
    s_nop 1
    v_permlane32_swap_b32 v2, v3
    s_nop 1
    v_max_f32 v2, v2, v3
    v_add_f32 v2, s47, v2
    v_sub_f32 v128, 0, v2
    v_mov_b32 v129, v128
    v_mov_b32 v130, v128
    v_mov_b32 v131, v128
    v_mov_b32 v132, v128
    v_mov_b32 v133, v128
    v_mov_b32 v134, v128
    v_mov_b32 v135, v128
    v_mov_b32 v136, v128
    v_mov_b32 v137, v128
    v_mov_b32 v138, v128
    v_mov_b32 v139, v128
    v_mov_b32 v140, v128
    v_mov_b32 v141, v128
    v_mov_b32 v142, v128
    v_mov_b32 v143, v128
    v_max3_f32 v2, v16, v17, v18
    v_max3_f32 v2, v2, v19, v20
    v_max3_f32 v2, v2, v21, v22
    v_max3_f32 v2, v2, v23, v24
    v_max3_f32 v2, v2, v25, v26
    v_max3_f32 v2, v2, v27, v28
    v_max3_f32 v2, v2, v29, v30
    v_max_f32 v2, v2, v31
    v_mov_b32 v3, v2
    s_nop 1
    v_permlane32_swap_b32 v2, v3
    s_nop 1
    v_max_f32 v2, v2, v3
    v_add_f32 v2, s47, v2
    v_sub_f32 v112, 0, v2
    v_mov_b32 v113, v112
    v_mov_b32 v114, v112
    v_mov_b32 v115, v112
    v_mov_b32 v116, v112
    v_mov_b32 v117, v112
    v_mov_b32 v118, v112
    v_mov_b32 v119, v112
    v_mov_b32 v120, v112
    v_mov_b32 v121, v112
    v_mov_b32 v122, v112
    v_mov_b32 v123, v112
    v_mov_b32 v124, v112
    v_mov_b32 v125, v112
    v_mov_b32 v126, v112
    v_mov_b32 v127, v112
    s_waitcnt lgkmcnt(0)
    ds_add_u32 v254, v255
    s_add_u32 s48, s48, 2
    v_mov_b32 v12, 0
    v_mov_b32 v13, 0
    v_mov_b32 v14, 0
    v_mov_b32 v15, 0
    v_mov_b32 v248, 0
    v_mov_b32 v249, 0
    v_mov_b32 v250, 0
    v_mov_b32 v251, 0
    v_mov_b32 v252, 0
    v_mov_b32 v253, 0
    v_mov_b32 v254, 0
    v_mov_b32 v255, 0
    v_mfma_f32_32x32x16_bf16 v[32:47], v[192:195], v[184:187], 0
    v_mfma_f32_32x32x16_bf16 v[32:47], v[196:199], v[188:191], v[32:47]
    v_mfma_f32_32x32x16_bf16 v[16:31], v[192:195], v[176:179], 0
    v_mfma_f32_32x32x16_bf16 v[16:31], v[196:199], v[180:183], v[16:31]
    s_nop 10
    v_max3_f32 v2, v32, v33, v34
    v_max3_f32 v2, v2, v35, v36
    v_max3_f32 v2, v2, v37, v38
    v_max3_f32 v2, v2, v39, v40
    v_max3_f32 v2, v2, v41, v42
    v_max3_f32 v2, v2, v43, v44
    v_max3_f32 v2, v2, v45, v46
    v_max_f32 v2, v2, v47
    v_mov_b32 v3, v2
    s_nop 1
    v_permlane32_swap_b32 v2, v3
    s_nop 1
    v_max_f32 v2, v2, v3
    v_add_f32 v2, s47, v2
    v_sub_f32 v232, 0, v2
    v_mov_b32 v233, v232
    v_mov_b32 v234, v232
    v_mov_b32 v235, v232
    v_mov_b32 v236, v232
    v_mov_b32 v237, v232
    v_mov_b32 v238, v232
    v_mov_b32 v239, v232
    v_mov_b32 v240, v232
    v_mov_b32 v241, v232
    v_mov_b32 v242, v232
    v_mov_b32 v243, v232
    v_mov_b32 v244, v232
    v_mov_b32 v245, v232
    v_mov_b32 v246, v232
    v_mov_b32 v247, v232
    v_max3_f32 v2, v16, v17, v18
    v_max3_f32 v2, v2, v19, v20
    v_max3_f32 v2, v2, v21, v22
    v_max3_f32 v2, v2, v23, v24
    v_max3_f32 v2, v2, v25, v26
    v_max3_f32 v2, v2, v27, v28
    v_max3_f32 v2, v2, v29, v30
    v_max_f32 v2, v2, v31
    v_mov_b32 v3, v2
    s_nop 1
    v_permlane32_swap_b32 v2, v3
    s_nop 1
    v_max_f32 v2, v2, v3
    v_add_f32 v2, s47, v2
    v_sub_f32 v144, 0, v2
    v_mov_b32 v145, v144
    v_mov_b32 v146, v144
    v_mov_b32 v147, v144
    v_mov_b32 v148, v144
    v_mov_b32 v149, v144
    v_mov_b32 v150, v144
    v_mov_b32 v151, v144
    v_mov_b32 v152, v144
    v_mov_b32 v153, v144
    v_mov_b32 v154, v144
    v_mov_b32 v155, v144
    v_mov_b32 v156, v144
    v_mov_b32 v157, v144
    v_mov_b32 v158, v144
    v_mov_b32 v159, v144
    s_nop 1
    v_mfma_f32_32x32x16_bf16 v[16:31], v[192:195], v[160:163], v[112:127]
    v_mfma_f32_32x32x16_bf16 v[16:31], v[196:199], v[164:167], v[16:31]
    s_waitcnt vmcnt(0)
    v_lshrrev_b32 v6, 1, v1
    v_mov_b32 v2, s62
    v_mov_b32 v3, s63
    s_mov_b64 exec, 0xffff
    buffer_store_dwordx2 v[2:3], v6, s[12:15], s32 offen sc1
    s_mov_b64 exec, -1
    s_setprio 0
    s_nop 12
    v_exp_f32 v16, v16
    v_exp_f32 v17, v17
    v_exp_f32 v18, v18
    v_exp_f32 v19, v19
    v_exp_f32 v20, v20
    v_exp_f32 v21, v21
    v_mfma_f32_32x32x16_bf16 v[32:47], v[192:195], v[168:171], v[128:143]
    v_exp_f32 v22, v22
    v_exp_f32 v23, v23
    v_exp_f32 v24, v24
    v_mfma_f32_32x32x16_bf16 v[32:47], v[196:199], v[172:175], v[32:47]
    s_nop 0
    v_exp_f32 v25, v25
    v_exp_f32 v26, v26
    v_exp_f32 v27, v27
    v_smfmac_f32_32x32x32_bf16 v[48:63], v[200:203], v[16:23], v4
    s_nop 0
    v_exp_f32 v28, v28
    v_exp_f32 v29, v29
    v_exp_f32 v30, v30
    v_smfmac_f32_16x16x64_bf16 v[12:15], v[8:11], v[16:23], v4
    s_nop 0
    v_exp_f32 v31, v31
    v_exp_f32 v32, v32
    v_exp_f32 v33, v33
    v_smfmac_f32_32x32x32_bf16 v[48:63], v[204:207], v[24:31], v4
    v_exp_f32 v34, v34
    v_exp_f32 v35, v35
    v_exp_f32 v36, v36
    v_smfmac_f32_16x16x64_bf16 v[12:15], v[8:11], v[24:31], v4
    v_exp_f32 v37, v37
    v_mfma_f32_32x32x16_bf16 v[16:31], v[192:195], v[176:179], v[144:159]
    v_exp_f32 v38, v38
    v_exp_f32 v39, v39
    v_exp_f32 v40, v40
    v_mfma_f32_32x32x16_bf16 v[16:31], v[196:199], v[180:183], v[16:31]
    s_nop 0
    v_exp_f32 v41, v41
    v_exp_f32 v42, v42
    v_exp_f32 v43, v43
    v_smfmac_f32_32x32x32_bf16 v[64:79], v[200:203], v[32:39], v4
    s_nop 0
    v_exp_f32 v44, v44
    v_exp_f32 v45, v45
    v_exp_f32 v46, v46
    v_smfmac_f32_16x16x64_bf16 v[248:251], v[8:11], v[32:39], v4
    s_nop 0
    v_exp_f32 v47, v47
    v_exp_f32 v16, v16
    v_exp_f32 v17, v17
    v_smfmac_f32_32x32x32_bf16 v[64:79], v[204:207], v[40:47], v4
    v_exp_f32 v18, v18
    v_exp_f32 v19, v19
    v_exp_f32 v20, v20
    v_smfmac_f32_16x16x64_bf16 v[248:251], v[8:11], v[40:47], v4
    v_exp_f32 v21, v21
    v_mfma_f32_32x32x16_bf16 v[32:47], v[192:195], v[184:187], v[232:247]
    v_exp_f32 v22, v22
    v_exp_f32 v23, v23
    v_exp_f32 v24, v24
    v_mfma_f32_32x32x16_bf16 v[32:47], v[196:199], v[188:191], v[32:47]
    s_nop 0
    v_exp_f32 v25, v25
    v_exp_f32 v26, v26
    v_exp_f32 v27, v27
    v_smfmac_f32_32x32x32_bf16 v[80:95], v[200:203], v[16:23], v4
    s_nop 0
    v_exp_f32 v28, v28
    v_exp_f32 v29, v29
    v_exp_f32 v30, v30
    v_smfmac_f32_16x16x64_bf16 v[250:253], v[8:11], v[16:23], v4
    s_nop 0
    v_exp_f32 v31, v31
    v_exp_f32 v32, v32
    v_exp_f32 v33, v33
    v_smfmac_f32_32x32x32_bf16 v[80:95], v[204:207], v[24:31], v4
    v_exp_f32 v34, v34
    v_exp_f32 v35, v35
    v_exp_f32 v36, v36
    v_smfmac_f32_16x16x64_bf16 v[250:253], v[8:11], v[24:31], v4
    v_exp_f32 v37, v37
    v_mfma_f32_32x32x16_bf16 v[16:31], v[208:211], v[160:163], v[112:127]
    v_exp_f32 v38, v38
    v_exp_f32 v39, v39
    v_exp_f32 v40, v40
    v_mfma_f32_32x32x16_bf16 v[16:31], v[212:215], v[164:167], v[16:31]
    s_nop 0
    v_exp_f32 v41, v41
    v_exp_f32 v42, v42
    v_exp_f32 v43, v43
    v_smfmac_f32_32x32x32_bf16 v[96:111], v[200:203], v[32:39], v4
    s_nop 0
    v_exp_f32 v44, v44
    v_exp_f32 v45, v45
    v_exp_f32 v46, v46
    v_smfmac_f32_16x16x64_bf16 v[252:255], v[8:11], v[32:39], v4
    s_nop 0
    v_exp_f32 v47, v47
    v_exp_f32 v16, v16
    v_exp_f32 v17, v17
    v_smfmac_f32_32x32x32_bf16 v[96:111], v[204:207], v[40:47], v4
    v_exp_f32 v18, v18
    v_exp_f32 v19, v19
    v_exp_f32 v20, v20
    v_smfmac_f32_16x16x64_bf16 v[252:255], v[8:11], v[40:47], v4
    v_exp_f32 v21, v21
    v_mfma_f32_32x32x16_bf16 v[32:47], v[208:211], v[168:171], v[128:143]
    v_exp_f32 v22, v22
    v_exp_f32 v23, v23
    v_exp_f32 v24, v24
    v_mfma_f32_32x32x16_bf16 v[32:47], v[212:215], v[172:175], v[32:47]
    s_nop 0
    v_exp_f32 v25, v25
    v_exp_f32 v26, v26
    v_exp_f32 v27, v27
    v_smfmac_f32_32x32x32_bf16 v[48:63], v[216:219], v[16:23], v4
    s_nop 0
    v_exp_f32 v28, v28
    v_exp_f32 v29, v29
    v_exp_f32 v30, v30
    v_smfmac_f32_16x16x64_bf16 v[12:15], v[8:11], v[16:23], v4
    s_nop 0
    v_exp_f32 v31, v31
    v_exp_f32 v32, v32
    v_exp_f32 v33, v33
    v_smfmac_f32_32x32x32_bf16 v[48:63], v[220:223], v[24:31], v4
    v_exp_f32 v34, v34
    v_exp_f32 v35, v35
    v_exp_f32 v36, v36
    v_smfmac_f32_16x16x64_bf16 v[12:15], v[8:11], v[24:31], v4
    v_exp_f32 v37, v37
    v_mfma_f32_32x32x16_bf16 v[16:31], v[208:211], v[176:179], v[144:159]
    v_exp_f32 v38, v38
    v_exp_f32 v39, v39
    v_exp_f32 v40, v40
    v_mfma_f32_32x32x16_bf16 v[16:31], v[212:215], v[180:183], v[16:31]
    s_nop 0
    v_exp_f32 v41, v41
    v_exp_f32 v42, v42
    v_exp_f32 v43, v43
    v_smfmac_f32_32x32x32_bf16 v[64:79], v[216:219], v[32:39], v4
    s_nop 0
    v_exp_f32 v44, v44
    v_exp_f32 v45, v45
    v_exp_f32 v46, v46
    v_smfmac_f32_16x16x64_bf16 v[248:251], v[8:11], v[32:39], v4
    s_nop 0
    v_exp_f32 v47, v47
    v_exp_f32 v16, v16
    v_exp_f32 v17, v17
    v_smfmac_f32_32x32x32_bf16 v[64:79], v[220:223], v[40:47], v4
    v_exp_f32 v18, v18
    v_exp_f32 v19, v19
    v_exp_f32 v20, v20
    v_smfmac_f32_16x16x64_bf16 v[248:251], v[8:11], v[40:47], v4
    v_exp_f32 v21, v21
    v_mfma_f32_32x32x16_bf16 v[32:47], v[208:211], v[184:187], v[232:247]
    v_exp_f32 v22, v22
    v_exp_f32 v23, v23
    v_exp_f32 v24, v24
    v_mfma_f32_32x32x16_bf16 v[32:47], v[212:215], v[188:191], v[32:47]
    s_nop 0
    v_exp_f32 v25, v25
    v_exp_f32 v26, v26
    v_exp_f32 v27, v27
    v_smfmac_f32_32x32x32_bf16 v[80:95], v[216:219], v[16:23], v4
    s_nop 0
    v_exp_f32 v28, v28
    v_exp_f32 v29, v29
    v_exp_f32 v30, v30
    v_smfmac_f32_16x16x64_bf16 v[250:253], v[8:11], v[16:23], v4
    s_nop 0
    v_exp_f32 v31, v31
    v_exp_f32 v32, v32
    v_exp_f32 v33, v33
    v_smfmac_f32_32x32x32_bf16 v[80:95], v[220:223], v[24:31], v4
    v_exp_f32 v34, v34
    v_exp_f32 v35, v35
    v_exp_f32 v36, v36
    v_smfmac_f32_16x16x64_bf16 v[250:253], v[8:11], v[24:31], v4
    v_exp_f32 v37, v37
    v_exp_f32 v38, v38
    v_exp_f32 v39, v39
    v_exp_f32 v40, v40
    s_nop 0
    v_exp_f32 v41, v41
    v_exp_f32 v42, v42
    v_exp_f32 v43, v43
    v_smfmac_f32_32x32x32_bf16 v[96:111], v[216:219], v[32:39], v4
    s_nop 0
    v_exp_f32 v44, v44
    v_exp_f32 v45, v45
    v_exp_f32 v46, v46
    v_smfmac_f32_16x16x64_bf16 v[252:255], v[8:11], v[32:39], v4
    s_nop 0
    v_exp_f32 v47, v47
    s_nop 1
    v_smfmac_f32_32x32x32_bf16 v[96:111], v[220:223], v[40:47], v4
    v_smfmac_f32_16x16x64_bf16 v[252:255], v[8:11], v[40:47], v4
    s_mov_b32 s44, 2
    s_mov_b32 s45, 0
    s_lshr_b32 s50, s44, 1
    s_add_u32 s50, s50, s35
    s_and_b32 s50, s50, 15
    s_bitcmp1_b32 s56, s50
    s_cbranch_scc0 L_xw_p0
L_xwd_p0:
    s_lshl_b32 s50, s50, 14
    s_add_u32 s61, s38, s50
    s_and_b32 s50, s44, 1
    s_lshl_b32 s50, s50, 12
    s_add_u32 s44, s44, 1
    s_add_u32 s60, s61, s50
    buffer_load_dwordx4 v[192:195], v1, s[12:15], s60 offen offset:0 sc1
    buffer_load_dwordx4 v[196:199], v1, s[12:15], s60 offen offset:1024 sc1
    buffer_load_dwordx4 v[200:203], v1, s[12:15], s60 offen offset:2048 sc1
    buffer_load_dwordx4 v[204:207], v1, s[12:15], s60 offen offset:3072 sc1
    s_lshr_b32 s50, s44, 1
    s_add_u32 s50, s50, s35
    s_and_b32 s50, s50, 15
    s_bitcmp1_b32 s56, s50
    s_cbranch_scc0 L_xw_p4
L_xwd_p4:
    s_lshl_b32 s50, s50, 14
    s_add_u32 s61, s38, s50
    s_and_b32 s50, s44, 1
    s_lshl_b32 s50, s50, 12
    s_add_u32 s44, s44, 1
    s_add_u32 s60, s61, s50
    buffer_load_dwordx4 v[208:211], v1, s[12:15], s60 offen offset:0 sc1
    buffer_load_dwordx4 v[212:215], v1, s[12:15], s60 offen offset:1024 sc1
    buffer_load_dwordx4 v[216:219], v1, s[12:15], s60 offen offset:2048 sc1
    buffer_load_dwordx4 v[220:223], v1, s[12:15], s60 offen offset:3072 sc1
    s_lshr_b32 s50, s44, 1
    s_add_u32 s50, s50, s35
    s_and_b32 s50, s50, 15
    s_bitcmp1_b32 s56, s50
    s_cbranch_scc0 L_xw_p8
L_xwd_p8:
    s_lshl_b32 s50, s50, 14
    s_add_u32 s61, s38, s50
    s_and_b32 s50, s44, 1
    s_lshl_b32 s50, s50, 12
    s_add_u32 s44, s44, 1
    s_add_u32 s60, s61, s50
    buffer_load_dwordx4 v[224:227], v1, s[12:15], s60 offen offset:0 sc1
    v_mov_b32 v228, 0
    v_mov_b32 v229, 0
    v_mov_b32 v230, 0
    v_mov_b32 v231, 0
    v_mov_b32 v40, 0
    v_mov_b32 v41, 0
    v_mov_b32 v42, 0
    v_mov_b32 v43, 0
    v_mov_b32 v44, 0
    v_mov_b32 v45, 0
    v_mov_b32 v46, 0
    v_mov_b32 v47, 0
    s_waitcnt vmcnt(7)
    v_mfma_f32_32x32x16_bf16 v[16:31], v[192:195], v[160:163], v[112:127]
    v_mfma_f32_32x32x16_bf16 v[16:31], v[196:199], v[164:167], v[16:31]
    s_nop 12
.p2align 6
L_x_loop:
    v_exp_f32 v16, v16
    v_exp_f32 v17, v17
    v_smfmac_f32_32x32x32_bf16 v[96:111], v[228:231], v[40:47], v4
    buffer_load_dwordx4 v[228:231], v1, s[12:15], s60 offen offset:1024 sc1
    v_exp_f32 v18, v18
    v_exp_f32 v19, v19
    v_exp_f32 v20, v20
    v_smfmac_f32_16x16x64_bf16 v[252:255], v[8:11], v[40:47], v4
    s_lshr_b32 s50, s44, 1
    v_exp_f32 v21, v21
    v_mfma_f32_32x32x16_bf16 v[32:47], v[192:195], v[168:171], v[128:143]
    s_add_u32 s50, s50, s35
    v_exp_f32 v22, v22
    v_exp_f32 v23, v23
    v_exp_f32 v24, v24
    v_mfma_f32_32x32x16_bf16 v[32:47], v[196:199], v[172:175], v[32:47]
    s_waitcnt vmcnt(7)
    v_exp_f32 v25, v25
    v_exp_f32 v26, v26
    v_exp_f32 v27, v27
    v_smfmac_f32_32x32x32_bf16 v[48:63], v[200:203], v[16:23], v4
    s_and_b32 s50, s50, 15
    v_exp_f32 v28, v28
    v_exp_f32 v29, v29
    v_exp_f32 v30, v30
    v_smfmac_f32_16x16x64_bf16 v[12:15], v[8:11], v[16:23], v4
    s_waitcnt vmcnt(6)
    v_exp_f32 v31, v31
    v_exp_f32 v32, v32
    v_exp_f32 v33, v33
    v_smfmac_f32_32x32x32_bf16 v[48:63], v[204:207], v[24:31], v4
    s_bitcmp1_b32 s56, s50
    v_exp_f32 v34, v34
    v_exp_f32 v35, v35
    v_exp_f32 v36, v36
    v_smfmac_f32_16x16x64_bf16 v[12:15], v[8:11], v[24:31], v4
    s_cbranch_scc0 L_xw_b0
L_xwd_b0:
    v_exp_f32 v37, v37
    v_mfma_f32_32x32x16_bf16 v[16:31], v[192:195], v[176:179], v[144:159]
    s_lshl_b32 s50, s50, 14
    v_exp_f32 v38, v38
    v_exp_f32 v39, v39
    v_exp_f32 v40, v40
    v_mfma_f32_32x32x16_bf16 v[16:31], v[196:199], v[180:183], v[16:31]
    s_add_u32 s61, s38, s50
    v_exp_f32 v41, v41
    v_exp_f32 v42, v42
    v_exp_f32 v43, v43
    v_smfmac_f32_32x32x32_bf16 v[64:79], v[200:203], v[32:39], v4
    s_and_b32 s50, s44, 1
    v_exp_f32 v44, v44
    v_exp_f32 v45, v45
    v_exp_f32 v46, v46
    v_smfmac_f32_16x16x64_bf16 v[248:251], v[8:11], v[32:39], v4
    s_lshl_b32 s50, s50, 12
    v_exp_f32 v47, v47
    v_exp_f32 v16, v16
    v_exp_f32 v17, v17
    v_smfmac_f32_32x32x32_bf16 v[64:79], v[204:207], v[40:47], v4
    s_add_u32 s44, s44, 1
    v_exp_f32 v18, v18
    v_exp_f32 v19, v19
    v_exp_f32 v20, v20
    v_smfmac_f32_16x16x64_bf16 v[248:251], v[8:11], v[40:47], v4
    v_exp_f32 v21, v21
    v_mfma_f32_32x32x16_bf16 v[32:47], v[192:195], v[184:187], v[232:247]
    buffer_load_dwordx4 v[192:195], v1, s[12:15], s60 offen offset:2048 sc1
    v_exp_f32 v22, v22
    v_exp_f32 v23, v23
    v_exp_f32 v24, v24
    v_mfma_f32_32x32x16_bf16 v[32:47], v[196:199], v[188:191], v[32:47]
    buffer_load_dwordx4 v[196:199], v1, s[12:15], s60 offen offset:3072 sc1
    v_exp_f32 v25, v25
    v_exp_f32 v26, v26
    v_exp_f32 v27, v27
    v_smfmac_f32_32x32x32_bf16 v[80:95], v[200:203], v[16:23], v4
    s_nop 0
    v_exp_f32 v28, v28
    v_exp_f32 v29, v29
    v_exp_f32 v30, v30
    v_smfmac_f32_16x16x64_bf16 v[250:253], v[8:11], v[16:23], v4
    s_add_u32 s60, s61, s50
    v_exp_f32 v31, v31
    v_exp_f32 v32, v32
    v_exp_f32 v33, v33
    v_smfmac_f32_32x32x32_bf16 v[80:95], v[204:207], v[24:31], v4
    v_exp_f32 v34, v34
    v_exp_f32 v35, v35
    v_exp_f32 v36, v36
    v_smfmac_f32_16x16x64_bf16 v[250:253], v[8:11], v[24:31], v4
    s_waitcnt vmcnt(7)
    v_exp_f32 v37, v37
    v_mfma_f32_32x32x16_bf16 v[16:31], v[208:211], v[160:163], v[112:127]
    s_waitcnt vmcnt(6)
    v_exp_f32 v38, v38
    v_exp_f32 v39, v39
    v_exp_f32 v40, v40
    v_mfma_f32_32x32x16_bf16 v[16:31], v[212:215], v[164:167], v[16:31]
    s_nop 0
    v_exp_f32 v41, v41
    v_exp_f32 v42, v42
    v_exp_f32 v43, v43
    v_smfmac_f32_32x32x32_bf16 v[96:111], v[200:203], v[32:39], v4
    buffer_load_dwordx4 v[200:203], v1, s[12:15], s60 offen offset:0 sc1
    v_exp_f32 v44, v44
    v_exp_f32 v45, v45
    v_exp_f32 v46, v46
    v_smfmac_f32_16x16x64_bf16 v[252:255], v[8:11], v[32:39], v4
    s_nop 0
    v_exp_f32 v47, v47
    v_exp_f32 v16, v16
    v_exp_f32 v17, v17
    v_smfmac_f32_32x32x32_bf16 v[96:111], v[204:207], v[40:47], v4
    buffer_load_dwordx4 v[204:207], v1, s[12:15], s60 offen offset:1024 sc1
    v_exp_f32 v18, v18
    v_exp_f32 v19, v19
    v_exp_f32 v20, v20
    v_smfmac_f32_16x16x64_bf16 v[252:255], v[8:11], v[40:47], v4
    s_lshr_b32 s50, s44, 1
    v_exp_f32 v21, v21
    v_mfma_f32_32x32x16_bf16 v[32:47], v[208:211], v[168:171], v[128:143]
    s_add_u32 s50, s50, s35
    v_exp_f32 v22, v22
    v_exp_f32 v23, v23
    v_exp_f32 v24, v24
    v_mfma_f32_32x32x16_bf16 v[32:47], v[212:215], v[172:175], v[32:47]
    s_waitcnt vmcnt(7)
    v_exp_f32 v25, v25
    v_exp_f32 v26, v26
    v_exp_f32 v27, v27
    v_smfmac_f32_32x32x32_bf16 v[48:63], v[216:219], v[16:23], v4
    s_and_b32 s50, s50, 15
    v_exp_f32 v28, v28
    v_exp_f32 v29, v29
    v_exp_f32 v30, v30
    v_smfmac_f32_16x16x64_bf16 v[12:15], v[8:11], v[16:23], v4
    s_waitcnt vmcnt(6)
    v_exp_f32 v31, v31
    v_exp_f32 v32, v32
    v_exp_f32 v33, v33
    v_smfmac_f32_32x32x32_bf16 v[48:63], v[220:223], v[24:31], v4
    s_bitcmp1_b32 s56, s50
    v_exp_f32 v34, v34
    v_exp_f32 v35, v35
    v_exp_f32 v36, v36
    v_smfmac_f32_16x16x64_bf16 v[12:15], v[8:11], v[24:31], v4
    s_cbranch_scc0 L_xw_b1
L_xwd_b1:
    v_exp_f32 v37, v37
    v_mfma_f32_32x32x16_bf16 v[16:31], v[208:211], v[176:179], v[144:159]
    s_lshl_b32 s50, s50, 14
    v_exp_f32 v38, v38
    v_exp_f32 v39, v39
    v_exp_f32 v40, v40
    v_mfma_f32_32x32x16_bf16 v[16:31], v[212:215], v[180:183], v[16:31]
    s_add_u32 s61, s38, s50
    v_exp_f32 v41, v41
    v_exp_f32 v42, v42
    v_exp_f32 v43, v43
    v_smfmac_f32_32x32x32_bf16 v[64:79], v[216:219], v[32:39], v4
    s_and_b32 s50, s44, 1
    v_exp_f32 v44, v44
    v_exp_f32 v45, v45
    v_exp_f32 v46, v46
    v_smfmac_f32_16x16x64_bf16 v[248:251], v[8:11], v[32:39], v4
    s_lshl_b32 s50, s50, 12
    v_exp_f32 v47, v47
    v_exp_f32 v16, v16
    v_exp_f32 v17, v17
    v_smfmac_f32_32x32x32_bf16 v[64:79], v[220:223], v[40:47], v4
    s_add_u32 s44, s44, 1
    v_exp_f32 v18, v18
    v_exp_f32 v19, v19
    v_exp_f32 v20, v20
    v_smfmac_f32_16x16x64_bf16 v[248:251], v[8:11], v[40:47], v4
    v_exp_f32 v21, v21
    v_mfma_f32_32x32x16_bf16 v[32:47], v[208:211], v[184:187], v[232:247]
    buffer_load_dwordx4 v[208:211], v1, s[12:15], s60 offen offset:2048 sc1
    v_exp_f32 v22, v22
    v_exp_f32 v23, v23
    v_exp_f32 v24, v24
    v_mfma_f32_32x32x16_bf16 v[32:47], v[212:215], v[188:191], v[32:47]
    buffer_load_dwordx4 v[212:215], v1, s[12:15], s60 offen offset:3072 sc1
    v_exp_f32 v25, v25
    v_exp_f32 v26, v26
    v_exp_f32 v27, v27
    v_smfmac_f32_32x32x32_bf16 v[80:95], v[216:219], v[16:23], v4
    s_nop 0
    v_exp_f32 v28, v28
    v_exp_f32 v29, v29
    v_exp_f32 v30, v30
    v_smfmac_f32_16x16x64_bf16 v[250:253], v[8:11], v[16:23], v4
    s_add_u32 s60, s61, s50
    v_exp_f32 v31, v31
    v_exp_f32 v32, v32
    v_exp_f32 v33, v33
    v_smfmac_f32_32x32x32_bf16 v[80:95], v[220:223], v[24:31], v4
    v_exp_f32 v34, v34
    v_exp_f32 v35, v35
    v_exp_f32 v36, v36
    v_smfmac_f32_16x16x64_bf16 v[250:253], v[8:11], v[24:31], v4
    s_waitcnt vmcnt(7)
    v_exp_f32 v37, v37
    v_mfma_f32_32x32x16_bf16 v[16:31], v[224:227], v[160:163], v[112:127]
    s_waitcnt vmcnt(6)
    v_exp_f32 v38, v38
    v_exp_f32 v39, v39
    v_exp_f32 v40, v40
    v_mfma_f32_32x32x16_bf16 v[16:31], v[228:231], v[164:167], v[16:31]
    s_nop 0
    v_exp_f32 v41, v41
    v_exp_f32 v42, v42
    v_exp_f32 v43, v43
    v_smfmac_f32_32x32x32_bf16 v[96:111], v[216:219], v[32:39], v4
    buffer_load_dwordx4 v[216:219], v1, s[12:15], s60 offen offset:0 sc1
    v_exp_f32 v44, v44
    v_exp_f32 v45, v45
    v_max3_f32 v2, v12, v248, v250
    v_max_f32 v2, v2, v252
    v_cmp_lt_f32 vcc, s46, v2
    v_exp_f32 v46, v46
    v_smfmac_f32_16x16x64_bf16 v[252:255], v[8:11], v[32:39], v4
    s_cbranch_vccnz L_resc_x1
L_back_x1:
    v_exp_f32 v47, v47
    v_exp_f32 v16, v16
    v_exp_f32 v17, v17
    v_smfmac_f32_32x32x32_bf16 v[96:111], v[220:223], v[40:47], v4
    buffer_load_dwordx4 v[220:223], v1, s[12:15], s60 offen offset:1024 sc1
    v_exp_f32 v18, v18
    v_exp_f32 v19, v19
    v_exp_f32 v20, v20
    v_smfmac_f32_16x16x64_bf16 v[252:255], v[8:11], v[40:47], v4
    s_lshr_b32 s50, s44, 1
    v_exp_f32 v21, v21
    v_mfma_f32_32x32x16_bf16 v[32:47], v[224:227], v[168:171], v[128:143]
    s_add_u32 s50, s50, s35
    v_exp_f32 v22, v22
    v_exp_f32 v23, v23
    v_exp_f32 v24, v24
    v_mfma_f32_32x32x16_bf16 v[32:47], v[228:231], v[172:175], v[32:47]
    s_waitcnt vmcnt(7)
    v_exp_f32 v25, v25
    v_exp_f32 v26, v26
    v_exp_f32 v27, v27
    v_smfmac_f32_32x32x32_bf16 v[48:63], v[192:195], v[16:23], v4
    s_and_b32 s50, s50, 15
    v_exp_f32 v28, v28
    v_exp_f32 v29, v29
    v_exp_f32 v30, v30
    v_smfmac_f32_16x16x64_bf16 v[12:15], v[8:11], v[16:23], v4
    s_waitcnt vmcnt(6)
    v_exp_f32 v31, v31
    v_exp_f32 v32, v32
    v_exp_f32 v33, v33
    v_smfmac_f32_32x32x32_bf16 v[48:63], v[196:199], v[24:31], v4
    s_bitcmp1_b32 s56, s50
    v_exp_f32 v34, v34
    v_exp_f32 v35, v35
    v_exp_f32 v36, v36
    v_smfmac_f32_16x16x64_bf16 v[12:15], v[8:11], v[24:31], v4
    s_cbranch_scc0 L_xw_b2
L_xwd_b2:
    v_exp_f32 v37, v37
    v_mfma_f32_32x32x16_bf16 v[16:31], v[224:227], v[176:179], v[144:159]
    s_lshl_b32 s50, s50, 14
    v_exp_f32 v38, v38
    v_exp_f32 v39, v39
    v_exp_f32 v40, v40
    v_mfma_f32_32x32x16_bf16 v[16:31], v[228:231], v[180:183], v[16:31]
    s_add_u32 s61, s38, s50
    v_exp_f32 v41, v41
    v_exp_f32 v42, v42
    v_exp_f32 v43, v43
    v_smfmac_f32_32x32x32_bf16 v[64:79], v[192:195], v[32:39], v4
    s_and_b32 s50, s44, 1
    v_exp_f32 v44, v44
    v_exp_f32 v45, v45
    v_exp_f32 v46, v46
    v_smfmac_f32_16x16x64_bf16 v[248:251], v[8:11], v[32:39], v4
    s_lshl_b32 s50, s50, 12
    v_exp_f32 v47, v47
    v_exp_f32 v16, v16
    v_exp_f32 v17, v17
    v_smfmac_f32_32x32x32_bf16 v[64:79], v[196:199], v[40:47], v4
    s_add_u32 s44, s44, 1
    v_exp_f32 v18, v18
    v_exp_f32 v19, v19
    v_exp_f32 v20, v20
    v_smfmac_f32_16x16x64_bf16 v[248:251], v[8:11], v[40:47], v4
    v_exp_f32 v21, v21
    v_mfma_f32_32x32x16_bf16 v[32:47], v[224:227], v[184:187], v[232:247]
    buffer_load_dwordx4 v[224:227], v1, s[12:15], s60 offen offset:2048 sc1
    v_exp_f32 v22, v22
    v_exp_f32 v23, v23
    v_exp_f32 v24, v24
    v_mfma_f32_32x32x16_bf16 v[32:47], v[228:231], v[188:191], v[32:47]
    buffer_load_dwordx4 v[228:231], v1, s[12:15], s60 offen offset:3072 sc1
    v_exp_f32 v25, v25
    v_exp_f32 v26, v26
    v_exp_f32 v27, v27
    v_smfmac_f32_32x32x32_bf16 v[80:95], v[192:195], v[16:23], v4
    s_nop 0
    v_exp_f32 v28, v28
    v_exp_f32 v29, v29
    v_exp_f32 v30, v30
    v_smfmac_f32_16x16x64_bf16 v[250:253], v[8:11], v[16:23], v4
    s_add_u32 s60, s61, s50
    v_exp_f32 v31, v31
    v_exp_f32 v32, v32
    v_exp_f32 v33, v33
    v_smfmac_f32_32x32x32_bf16 v[80:95], v[196:199], v[24:31], v4
    v_exp_f32 v34, v34
    v_exp_f32 v35, v35
    v_exp_f32 v36, v36
    v_smfmac_f32_16x16x64_bf16 v[250:253], v[8:11], v[24:31], v4
    s_waitcnt vmcnt(7)
    v_exp_f32 v37, v37
    v_mfma_f32_32x32x16_bf16 v[16:31], v[200:203], v[160:163], v[112:127]
    s_waitcnt vmcnt(6)
    v_exp_f32 v38, v38
    v_exp_f32 v39, v39
    v_exp_f32 v40, v40
    v_mfma_f32_32x32x16_bf16 v[16:31], v[204:207], v[164:167], v[16:31]
    s_nop 0
    v_exp_f32 v41, v41
    v_exp_f32 v42, v42
    v_exp_f32 v43, v43
    v_smfmac_f32_32x32x32_bf16 v[96:111], v[192:195], v[32:39], v4
    buffer_load_dwordx4 v[192:195], v1, s[12:15], s60 offen offset:0 sc1
    v_exp_f32 v44, v44
    v_exp_f32 v45, v45
    v_exp_f32 v46, v46
    v_smfmac_f32_16x16x64_bf16 v[252:255], v[8:11], v[32:39], v4
    s_nop 0
    v_exp_f32 v47, v47
    v_exp_f32 v16, v16
    v_exp_f32 v17, v17
    v_smfmac_f32_32x32x32_bf16 v[96:111], v[196:199], v[40:47], v4
    buffer_load_dwordx4 v[196:199], v1, s[12:15], s60 offen offset:1024 sc1
    v_exp_f32 v18, v18
    v_exp_f32 v19, v19
    v_exp_f32 v20, v20
    v_smfmac_f32_16x16x64_bf16 v[252:255], v[8:11], v[40:47], v4
    s_lshr_b32 s50, s44, 1
    v_exp_f32 v21, v21
    v_mfma_f32_32x32x16_bf16 v[32:47], v[200:203], v[168:171], v[128:143]
    s_add_u32 s50, s50, s35
    v_exp_f32 v22, v22
    v_exp_f32 v23, v23
    v_exp_f32 v24, v24
    v_mfma_f32_32x32x16_bf16 v[32:47], v[204:207], v[172:175], v[32:47]
    s_waitcnt vmcnt(7)
    v_exp_f32 v25, v25
    v_exp_f32 v26, v26
    v_exp_f32 v27, v27
    v_smfmac_f32_32x32x32_bf16 v[48:63], v[208:211], v[16:23], v4
    s_and_b32 s50, s50, 15
    v_exp_f32 v28, v28
    v_exp_f32 v29, v29
    v_exp_f32 v30, v30
    v_smfmac_f32_16x16x64_bf16 v[12:15], v[8:11], v[16:23], v4
    s_waitcnt vmcnt(6)
    v_exp_f32 v31, v31
    v_exp_f32 v32, v32
    v_exp_f32 v33, v33
    v_smfmac_f32_32x32x32_bf16 v[48:63], v[212:215], v[24:31], v4
    s_bitcmp1_b32 s56, s50
    v_exp_f32 v34, v34
    v_exp_f32 v35, v35
    v_exp_f32 v36, v36
    v_smfmac_f32_16x16x64_bf16 v[12:15], v[8:11], v[24:31], v4
    s_cbranch_scc0 L_xw_b3
L_xwd_b3:
    v_exp_f32 v37, v37
    v_mfma_f32_32x32x16_bf16 v[16:31], v[200:203], v[176:179], v[144:159]
    s_lshl_b32 s50, s50, 14
    v_exp_f32 v38, v38
    v_exp_f32 v39, v39
    v_exp_f32 v40, v40
    v_mfma_f32_32x32x16_bf16 v[16:31], v[204:207], v[180:183], v[16:31]
    s_add_u32 s61, s38, s50
    v_exp_f32 v41, v41
    v_exp_f32 v42, v42
    v_exp_f32 v43, v43
    v_smfmac_f32_32x32x32_bf16 v[64:79], v[208:211], v[32:39], v4
    s_and_b32 s50, s44, 1
    v_exp_f32 v44, v44
    v_exp_f32 v45, v45
    v_exp_f32 v46, v46
    v_smfmac_f32_16x16x64_bf16 v[248:251], v[8:11], v[32:39], v4
    s_lshl_b32 s50, s50, 12
    v_exp_f32 v47, v47
    v_exp_f32 v16, v16
    v_exp_f32 v17, v17
    v_smfmac_f32_32x32x32_bf16 v[64:79], v[212:215], v[40:47], v4
    s_add_u32 s44, s44, 1
    v_exp_f32 v18, v18
    v_exp_f32 v19, v19
    v_exp_f32 v20, v20
    v_smfmac_f32_16x16x64_bf16 v[248:251], v[8:11], v[40:47], v4
    v_exp_f32 v21, v21
    v_mfma_f32_32x32x16_bf16 v[32:47], v[200:203], v[184:187], v[232:247]
    buffer_load_dwordx4 v[200:203], v1, s[12:15], s60 offen offset:2048 sc1
    v_exp_f32 v22, v22
    v_exp_f32 v23, v23
    v_exp_f32 v24, v24
    v_mfma_f32_32x32x16_bf16 v[32:47], v[204:207], v[188:191], v[32:47]
    buffer_load_dwordx4 v[204:207], v1, s[12:15], s60 offen offset:3072 sc1
    v_exp_f32 v25, v25
    v_exp_f32 v26, v26
    v_exp_f32 v27, v27
    v_smfmac_f32_32x32x32_bf16 v[80:95], v[208:211], v[16:23], v4
    s_nop 0
    v_exp_f32 v28, v28
    v_exp_f32 v29, v29
    v_exp_f32 v30, v30
    v_smfmac_f32_16x16x64_bf16 v[250:253], v[8:11], v[16:23], v4
    s_add_u32 s60, s61, s50
    v_exp_f32 v31, v31
    v_exp_f32 v32, v32
    v_exp_f32 v33, v33
    v_smfmac_f32_32x32x32_bf16 v[80:95], v[212:215], v[24:31], v4
    v_exp_f32 v34, v34
    v_exp_f32 v35, v35
    v_exp_f32 v36, v36
    v_smfmac_f32_16x16x64_bf16 v[250:253], v[8:11], v[24:31], v4
    s_waitcnt vmcnt(7)
    v_exp_f32 v37, v37
    v_mfma_f32_32x32x16_bf16 v[16:31], v[216:219], v[160:163], v[112:127]
    s_waitcnt vmcnt(6)
    v_exp_f32 v38, v38
    v_exp_f32 v39, v39
    v_exp_f32 v40, v40
    v_mfma_f32_32x32x16_bf16 v[16:31], v[220:223], v[164:167], v[16:31]
    s_nop 0
    v_exp_f32 v41, v41
    v_exp_f32 v42, v42
    v_exp_f32 v43, v43
    v_smfmac_f32_32x32x32_bf16 v[96:111], v[208:211], v[32:39], v4
    buffer_load_dwordx4 v[208:211], v1, s[12:15], s60 offen offset:0 sc1
    v_exp_f32 v44, v44
    v_exp_f32 v45, v45
    v_max3_f32 v2, v12, v248, v250
    v_max_f32 v2, v2, v252
    v_cmp_lt_f32 vcc, s46, v2
    v_exp_f32 v46, v46
    v_smfmac_f32_16x16x64_bf16 v[252:255], v[8:11], v[32:39], v4
    s_cbranch_vccnz L_resc_x3
L_back_x3:
    v_exp_f32 v47, v47
    v_exp_f32 v16, v16
    v_exp_f32 v17, v17
    v_smfmac_f32_32x32x32_bf16 v[96:111], v[212:215], v[40:47], v4
    buffer_load_dwordx4 v[212:215], v1, s[12:15], s60 offen offset:1024 sc1
    v_exp_f32 v18, v18
    v_exp_f32 v19, v19
    v_exp_f32 v20, v20
    v_smfmac_f32_16x16x64_bf16 v[252:255], v[8:11], v[40:47], v4
    s_lshr_b32 s50, s44, 1
    v_exp_f32 v21, v21
    v_mfma_f32_32x32x16_bf16 v[32:47], v[216:219], v[168:171], v[128:143]
    s_add_u32 s50, s50, s35
    v_exp_f32 v22, v22
    v_exp_f32 v23, v23
    v_exp_f32 v24, v24
    v_mfma_f32_32x32x16_bf16 v[32:47], v[220:223], v[172:175], v[32:47]
    s_waitcnt vmcnt(7)
    v_exp_f32 v25, v25
    v_exp_f32 v26, v26
    v_exp_f32 v27, v27
    v_smfmac_f32_32x32x32_bf16 v[48:63], v[224:227], v[16:23], v4
    s_and_b32 s50, s50, 15
    v_exp_f32 v28, v28
    v_exp_f32 v29, v29
    v_exp_f32 v30, v30
    v_smfmac_f32_16x16x64_bf16 v[12:15], v[8:11], v[16:23], v4
    s_waitcnt vmcnt(6)
    v_exp_f32 v31, v31
    v_exp_f32 v32, v32
    v_exp_f32 v33, v33
    v_smfmac_f32_32x32x32_bf16 v[48:63], v[228:231], v[24:31], v4
    s_bitcmp1_b32 s56, s50
    v_exp_f32 v34, v34
    v_exp_f32 v35, v35
    v_exp_f32 v36, v36
    v_smfmac_f32_16x16x64_bf16 v[12:15], v[8:11], v[24:31], v4
    s_cbranch_scc0 L_xw_b4
L_xwd_b4:
    v_exp_f32 v37, v37
    v_mfma_f32_32x32x16_bf16 v[16:31], v[216:219], v[176:179], v[144:159]
    s_lshl_b32 s50, s50, 14
    v_exp_f32 v38, v38
    v_exp_f32 v39, v39
    v_exp_f32 v40, v40
    v_mfma_f32_32x32x16_bf16 v[16:31], v[220:223], v[180:183], v[16:31]
    s_add_u32 s61, s38, s50
    v_exp_f32 v41, v41
    v_exp_f32 v42, v42
    v_exp_f32 v43, v43
    v_smfmac_f32_32x32x32_bf16 v[64:79], v[224:227], v[32:39], v4
    s_and_b32 s50, s44, 1
    v_exp_f32 v44, v44
    v_exp_f32 v45, v45
    v_exp_f32 v46, v46
    v_smfmac_f32_16x16x64_bf16 v[248:251], v[8:11], v[32:39], v4
    s_lshl_b32 s50, s50, 12
    v_exp_f32 v47, v47
    v_exp_f32 v16, v16
    v_exp_f32 v17, v17
    v_smfmac_f32_32x32x32_bf16 v[64:79], v[228:231], v[40:47], v4
    s_add_u32 s44, s44, 1
    v_exp_f32 v18, v18
    v_exp_f32 v19, v19
    v_exp_f32 v20, v20
    v_smfmac_f32_16x16x64_bf16 v[248:251], v[8:11], v[40:47], v4
    v_exp_f32 v21, v21
    v_mfma_f32_32x32x16_bf16 v[32:47], v[216:219], v[184:187], v[232:247]
    buffer_load_dwordx4 v[216:219], v1, s[12:15], s60 offen offset:2048 sc1
    v_exp_f32 v22, v22
    v_exp_f32 v23, v23
    v_exp_f32 v24, v24
    v_mfma_f32_32x32x16_bf16 v[32:47], v[220:223], v[188:191], v[32:47]
    buffer_load_dwordx4 v[220:223], v1, s[12:15], s60 offen offset:3072 sc1
    v_exp_f32 v25, v25
    v_exp_f32 v26, v26
    v_exp_f32 v27, v27
    v_smfmac_f32_32x32x32_bf16 v[80:95], v[224:227], v[16:23], v4
    s_nop 0
    v_exp_f32 v28, v28
    v_exp_f32 v29, v29
    v_exp_f32 v30, v30
    v_smfmac_f32_16x16x64_bf16 v[250:253], v[8:11], v[16:23], v4
    s_add_u32 s60, s61, s50
    v_exp_f32 v31, v31
    v_exp_f32 v32, v32
    v_exp_f32 v33, v33
    v_smfmac_f32_32x32x32_bf16 v[80:95], v[228:231], v[24:31], v4
    s_add_u32 s45, s45, 1
    v_exp_f32 v34, v34
    v_exp_f32 v35, v35
    v_exp_f32 v36, v36
    v_smfmac_f32_16x16x64_bf16 v[250:253], v[8:11], v[24:31], v4
    s_waitcnt vmcnt(7)
    v_exp_f32 v37, v37
    v_mfma_f32_32x32x16_bf16 v[16:31], v[192:195], v[160:163], v[112:127]
    s_waitcnt vmcnt(6)
    v_exp_f32 v38, v38
    v_exp_f32 v39, v39
    v_exp_f32 v40, v40
    v_mfma_f32_32x32x16_bf16 v[16:31], v[196:199], v[164:167], v[16:31]
    s_cmp_lt_u32 s45, 6
    v_exp_f32 v41, v41
    v_exp_f32 v42, v42
    v_exp_f32 v43, v43
    v_smfmac_f32_32x32x32_bf16 v[96:111], v[224:227], v[32:39], v4
    buffer_load_dwordx4 v[224:227], v1, s[12:15], s60 offen offset:0 sc1
    v_exp_f32 v44, v44
    v_exp_f32 v45, v45
    v_exp_f32 v46, v46
    v_smfmac_f32_16x16x64_bf16 v[252:255], v[8:11], v[32:39], v4
    s_nop 0
    v_exp_f32 v47, v47
    s_cbranch_scc1 L_x_loop
    s_nop 1
    v_smfmac_f32_32x32x32_bf16 v[96:111], v[228:231], v[40:47], v4
    v_smfmac_f32_16x16x64_bf16 v[252:255], v[8:11], v[40:47], v4
    s_setprio 3
    s_lshl_b32 s50, s37, 8
    s_add_u32 s50, s50, 162816
    v_lshrrev_b32 v30, 2, v1
    v_add_u32 v30, s50, v30
    v_mov_b32 v31, 1
    s_mov_b32 s100, 4194304
L_spin_x1b:
    ds_read_b32 v6, v30
    s_waitcnt lgkmcnt(0)
    v_cmp_le_u32 vcc, s48, v6
    s_cbranch_vccnz L_spind_x1b
    s_sleep 1
    s_sub_u32 s100, s100, 1
    s_cbranch_scc0 L_spin_x1b
L_spind_x1b:
    s_mul_i32 s40, s36, 9216
    s_xor_b32 s41, s40, 9216
    s_add_u32 s40, s40, s43
    s_add_u32 s41, s41, s43
    v_add_u32 v16, s40, v1
    v_add_u32 v17, s41, v1
    v_mov_b32 v20, v250
    v_mov_b32 v21, v144
    v_mov_b32 v23, v232
    ds_write_b128 v16, v[80:83] offset:0
    ds_write_b128 v16, v[84:87] offset:1024
    ds_write_b128 v16, v[88:91] offset:2048
    ds_write_b128 v16, v[92:95] offset:3072
    s_nop 1
    v_mov_b32 v22, v252
    ds_write_b128 v16, v[96:99] offset:4096
    ds_write_b128 v16, v[100:103] offset:5120
    ds_write_b128 v16, v[104:107] offset:6144
    ds_write_b128 v16, v[108:111] offset:7168
    ds_write_b128 v16, v[20:23] offset:8192
    ds_add_u32 v30, v31
    s_add_u32 s48, s48, 2
    s_mov_b32 s100, 4194304
L_spin_x2:
    ds_read_b32 v6, v30
    s_waitcnt lgkmcnt(0)
    v_cmp_le_u32 vcc, s48, v6
    s_cbranch_vccnz L_spind_x2
    s_sleep 1
    s_sub_u32 s100, s100, 1
    s_cbranch_scc0 L_spin_x2
L_spind_x2:
    ds_read_b128 v[20:23], v17 offset:8192
    ds_read_b128 v[80:83], v17 offset:0
    ds_read_b128 v[84:87], v17 offset:1024
    ds_read_b128 v[88:91], v17 offset:2048
    ds_read_b128 v[92:95], v17 offset:3072
    ds_read_b128 v[96:99], v17 offset:4096
    ds_read_b128 v[100:103], v17 offset:5120
    ds_read_b128 v[104:107], v17 offset:6144
    ds_read_b128 v[108:111], v17 offset:7168
    s_waitcnt lgkmcnt(8)
    v_frexp_exp_i32_f32 v28, v12
    v_frexp_exp_i32_f32 v29, v20
    v_cvt_f32_i32 v28, v28
    v_cvt_f32_i32 v29, v29
    v_sub_f32 v28, v28, v112
    v_sub_f32 v29, v29, v21
    v_max_f32 v28, v28, v29
    v_add_f32 v24, v112, v28
    v_add_f32 v25, v21, v28
    v_exp_f32 v24, -v24
    v_exp_f32 v25, -v25
    s_nop 0
    v_mul_f32 v12, v24, v12
    v_fma_f32 v12, v25, v20, v12
    v_rcp_f32 v28, v12
    v_mul_f32 v18, 0, v12
    v_mul_f32 v24, v28, v24
    v_mul_f32 v25, v28, v25
    v_mul_f32 v48, v24, v48
    v_mul_f32 v49, v24, v49
    v_mul_f32 v50, v24, v50
    v_mul_f32 v51, v24, v51
    v_mul_f32 v52, v24, v52
    v_mul_f32 v53, v24, v53
    v_mul_f32 v54, v24, v54
    v_mul_f32 v55, v24, v55
    v_mul_f32 v56, v24, v56
    v_mul_f32 v57, v24, v57
    v_mul_f32 v58, v24, v58
    v_mul_f32 v59, v24, v59
    v_mul_f32 v60, v24, v60
    v_mul_f32 v61, v24, v61
    v_mul_f32 v62, v24, v62
    v_mul_f32 v63, v24, v63
    v_frexp_exp_i32_f32 v28, v248
    v_frexp_exp_i32_f32 v29, v22
    v_cvt_f32_i32 v28, v28
    v_cvt_f32_i32 v29, v29
    v_sub_f32 v28, v28, v128
    v_sub_f32 v29, v29, v23
    v_max_f32 v28, v28, v29
    v_add_f32 v26, v128, v28
    v_add_f32 v27, v23, v28
    v_exp_f32 v26, -v26
    v_exp_f32 v27, -v27
    s_nop 0
    v_mul_f32 v248, v26, v248
    v_fma_f32 v248, v27, v22, v248
    v_rcp_f32 v28, v248
    v_mul_f32 v19, 0, v248
    v_mul_f32 v26, v28, v26
    v_mul_f32 v27, v28, v27
    v_mul_f32 v64, v26, v64
    v_mul_f32 v65, v26, v65
    v_mul_f32 v66, v26, v66
    v_mul_f32 v67, v26, v67
    v_mul_f32 v68, v26, v68
    v_mul_f32 v69, v26, v69
    v_mul_f32 v70, v26, v70
    v_mul_f32 v71, v26, v71
    v_mul_f32 v72, v26, v72
    v_mul_f32 v73, v26, v73
    v_mul_f32 v74, v26, v74
    v_mul_f32 v75, v26, v75
    v_mul_f32 v76, v26, v76
    v_mul_f32 v77, v26, v77
    v_mul_f32 v78, v26, v78
    v_mul_f32 v79, v26, v79
    s_lshl_b32 s50, s36, 13
    s_sub_u32 s38, s38, s50
    s_waitcnt lgkmcnt(0)
    v_fma_f32 v48, v25, v80, v48
    v_fma_f32 v49, v25, v81, v49
    v_fma_f32 v50, v25, v82, v50
    v_fma_f32 v51, v25, v83, v51
    v_fma_f32 v52, v25, v84, v52
    v_fma_f32 v53, v25, v85, v53
    v_fma_f32 v54, v25, v86, v54
    v_fma_f32 v55, v25, v87, v55
    v_fma_f32 v56, v25, v88, v56
    v_fma_f32 v57, v25, v89, v57
    v_fma_f32 v58, v25, v90, v58
    v_fma_f32 v59, v25, v91, v59
    v_fma_f32 v60, v25, v92, v60
    v_fma_f32 v61, v25, v93, v61
    v_fma_f32 v62, v25, v94, v62
    v_fma_f32 v63, v25, v95, v63
    v_fma_f32 v64, v27, v96, v64
    v_fma_f32 v65, v27, v97, v65
    v_fma_f32 v66, v27, v98, v66
    v_fma_f32 v67, v27, v99, v67
    v_fma_f32 v68, v27, v100, v68
    v_fma_f32 v69, v27, v101, v69
    v_fma_f32 v70, v27, v102, v70
    v_fma_f32 v71, v27, v103, v71
    v_fma_f32 v72, v27, v104, v72
    v_fma_f32 v73, v27, v105, v73
    v_fma_f32 v74, v27, v106, v74
    v_fma_f32 v75, v27, v107, v75
    v_fma_f32 v76, v27, v108, v76
    v_fma_f32 v77, v27, v109, v77
    v_fma_f32 v78, v27, v110, v78
    v_fma_f32 v79, v27, v111, v79
    v_fma_f32 v18, v48, 0, v18
    v_fma_f32 v18, v49, 0, v18
    v_fma_f32 v18, v50, 0, v18
    v_fma_f32 v18, v51, 0, v18
    v_fma_f32 v18, v52, 0, v18
    v_fma_f32 v18, v53, 0, v18
    v_fma_f32 v18, v54, 0, v18
    v_fma_f32 v18, v55, 0, v18
    v_fma_f32 v18, v56, 0, v18
    v_fma_f32 v18, v57, 0, v18
    v_fma_f32 v18, v58, 0, v18
    v_fma_f32 v18, v59, 0, v18
    v_fma_f32 v18, v60, 0, v18
    v_fma_f32 v18, v61, 0, v18
    v_fma_f32 v18, v62, 0, v18
    v_fma_f32 v18, v63, 0, v18
    v_fma_f32 v19, v64, 0, v19
    v_fma_f32 v19, v65, 0, v19
    v_fma_f32 v19, v66, 0, v19
    v_fma_f32 v19, v67, 0, v19
    v_fma_f32 v19, v68, 0, v19
    v_fma_f32 v19, v69, 0, v19
    v_fma_f32 v19, v70, 0, v19
    v_fma_f32 v19, v71, 0, v19
    v_fma_f32 v19, v72, 0, v19
    v_fma_f32 v19, v73, 0, v19
    v_fma_f32 v19, v74, 0, v19
    v_fma_f32 v19, v75, 0, v19
    v_fma_f32 v19, v76, 0, v19
    v_fma_f32 v19, v77, 0, v19
    v_fma_f32 v19, v78, 0, v19
    v_fma_f32 v19, v79, 0, v19
    v_cmp_u_f32 s[60:61], v18, v18
    v_cmp_u_f32 s[64:65], v19, v19
    s_nop 3
    s_cmp_lg_u64 s[60:61], 0
    s_cbranch_scc1 L_xslow0
L_xslowd0:
    v_cvt_pk_bf16_f32 v144, v48, v49
    v_cvt_pk_bf16_f32 v145, v50, v51
    v_cvt_pk_bf16_f32 v146, v52, v53
    v_cvt_pk_bf16_f32 v147, v54, v55
    v_cvt_pk_bf16_f32 v148, v56, v57
    v_cvt_pk_bf16_f32 v149, v58, v59
    v_cvt_pk_bf16_f32 v150, v60, v61
    v_cvt_pk_bf16_f32 v151, v62, v63
    buffer_store_dwordx4 v[144:147], v1, s[12:15], s42 offen sc1
    buffer_store_dwordx4 v[148:151], v1, s[12:15], s42 offen offset:1024 sc1
    s_add_u32 s42, s42, 65536
    s_cmp_lg_u64 s[64:65], 0
    s_cbranch_scc1 L_xslow1
L_xslowd1:
    v_cvt_pk_bf16_f32 v152, v64, v65
    v_cvt_pk_bf16_f32 v153, v66, v67
    v_cvt_pk_bf16_f32 v154, v68, v69
    v_cvt_pk_bf16_f32 v155, v70, v71
    v_cvt_pk_bf16_f32 v156, v72, v73
    v_cvt_pk_bf16_f32 v157, v74, v75
    v_cvt_pk_bf16_f32 v158, v76, v77
    v_cvt_pk_bf16_f32 v159, v78, v79
    buffer_store_dwordx4 v[152:155], v1, s[12:15], s42 offen sc1
    buffer_store_dwordx4 v[156:159], v1, s[12:15], s42 offen offset:1024 sc1
    s_lshl_b32 s49, s33, 1
    s_add_u32 s49, s49, s36
    s_lshl_b32 s49, s49, 12
    s_add_u32 s49, s49, 393216
    s_lshl_b32 s32, s34, 1
    s_add_u32 s32, s32, s37
    s_lshl_b32 s32, s32, 7
    s_add_u32 s32, s32, s49
    s_waitcnt vmcnt(0)
    v_lshrrev_b32 v6, 1, v1
    v_mov_b32 v2, s62
    v_mov_b32 v3, s63
    s_mov_b64 exec, 0xffff
    buffer_store_dwordx2 v[2:3], v6, s[12:15], s32 offen sc1
    s_mov_b64 exec, -1
L_f_end:
    s_endpgm
L_ys_a:
    s_mov_b32 s100, 4194304
L_spin_ya:
    ds_read_b32 v6, v254
    s_waitcnt lgkmcnt(0)
    v_cmp_le_u32 vcc, s48, v6
    s_cbranch_vccnz L_spind_ya
    s_sleep 1
    s_sub_u32 s100, s100, 1
    s_cbranch_scc0 L_spin_ya
L_spind_ya:
    s_branch L_ysd_a
L_ys_c:
    s_mov_b32 s100, 4194304
L_spin_yc:
    ds_read_b32 v6, v254
    s_waitcnt lgkmcnt(0)
    v_cmp_le_u32 vcc, s48, v6
    s_cbranch_vccnz L_spind_yc
    s_sleep 1
    s_sub_u32 s100, s100, 1
    s_cbranch_scc0 L_spin_yc
L_spind_yc:
    s_branch L_ysd_c
L_ys_b:
    s_mov_b32 s100, 4194304
L_spin_yb:
    ds_read_b32 v6, v254
    s_waitcnt lgkmcnt(0)
    v_cmp_le_u32 vcc, s48, v6
    s_cbranch_vccnz L_spind_yb
    s_sleep 1
    s_sub_u32 s100, s100, 1
    s_cbranch_scc0 L_spin_yb
L_spind_yb:
    s_branch L_ysd_b
L_non_y:
    s_mov_b32 s100, 262144
L_nonl_y:
    v_mov_b32 v6, 0
    global_load_dwordx4 v[12:15], v6, s[18:19] sc1
    s_waitcnt vmcnt(0)
    v_readfirstlane_b32 s62, v12
    v_readfirstlane_b32 s63, v13
    v_cmp_ne_u32 vcc, 0, v14
    s_cbranch_vccnz L_nond_y
    s_sleep 8
    s_sub_u32 s100, s100, 1
    s_cbranch_scc0 L_nonl_y
    s_branch L_nond_y
L_a_wt1:
    buffer_load_dword v225, v224, s[4:7], s44 offen
    s_branch L_a_wtd1
L_a_wt3:
    buffer_load_dword v225, v224, s[4:7], s44 offen
    s_branch L_a_wtd3
L_a_wt5:
    buffer_load_dword v225, v224, s[4:7], s44 offen
    s_branch L_a_wtd5
L_a_wt7:
    buffer_load_dword v225, v224, s[4:7], s44 offen
    s_branch L_a_wtd7
L_yp_poll:
    s_mov_b32 s100, 262144
L_poll_pp:
    v_lshlrev_b32 v2, 3, v1
    s_mov_b32 exec_hi, 0
    buffer_load_dwordx2 v[2:3], v2, s[12:15], s49 offen sc1
    s_waitcnt vmcnt(0)
    v_cmp_eq_u64 vcc, s[62:63], v[2:3]
    s_mov_b64 exec, -1
    s_nop 3
    s_or_b32 s56, s56, vcc_lo
    s_and_b32 s101, s56, s51
    s_cmp_eq_u32 s101, s51
    s_cbranch_scc1 L_polld_pp
    s_sleep 4
    s_sub_u32 s100, s100, 1
    s_cbranch_scc0 L_poll_pp
L_polld_pp:
    s_setpc_b64 s[44:45]
L_ypw_0:
    s_call_b64 s[44:45], L_yp_poll
    s_branch L_ypwd_0
L_ypw_1:
    s_call_b64 s[44:45], L_yp_poll
    s_branch L_ypwd_1
L_ypw_2:
    s_call_b64 s[44:45], L_yp_poll
    s_branch L_ypwd_2
L_ypw_3:
    s_call_b64 s[44:45], L_yp_poll
    s_branch L_ypwd_3
L_ypw_4:
    s_call_b64 s[44:45], L_yp_poll
    s_branch L_ypwd_4
L_ypw_5:
    s_call_b64 s[44:45], L_yp_poll
    s_branch L_ypwd_5
L_ypw_6:
    s_call_b64 s[44:45], L_yp_poll
    s_branch L_ypwd_6
L_yps_3:
    s_mov_b32 s100, 4194304
L_spin_pq3:
    ds_read_b32 v6, v254
    s_waitcnt lgkmcnt(0)
    v_cmp_le_u32 vcc, s48, v6
    s_cbranch_vccnz L_spind_pq3
    s_sleep 1
    s_sub_u32 s100, s100, 1
    s_cbranch_scc0 L_spin_pq3
L_spind_pq3:
    s_branch L_ypsd_3
L_ypw_7:
    s_call_b64 s[44:45], L_yp_poll
    s_branch L_ypwd_7
L_ypw_8:
    s_call_b64 s[44:45], L_yp_poll
    s_branch L_ypwd_8
L_yps_5:
    s_mov_b32 s100, 4194304
L_spin_pq5:
    ds_read_b32 v6, v254
    s_waitcnt lgkmcnt(0)
    v_cmp_le_u32 vcc, s48, v6
    s_cbranch_vccnz L_spind_pq5
    s_sleep 1
    s_sub_u32 s100, s100, 1
    s_cbranch_scc0 L_spin_pq5
L_spind_pq5:
    s_branch L_ypsd_5
L_ypw_9:
    s_call_b64 s[44:45], L_yp_poll
    s_branch L_ypwd_9
L_ypw_10:
    s_call_b64 s[44:45], L_yp_poll
    s_branch L_ypwd_10
L_yps_7:
    s_mov_b32 s100, 4194304
L_spin_pq7:
    ds_read_b32 v6, v254
    s_waitcnt lgkmcnt(0)
    v_cmp_le_u32 vcc, s48, v6
    s_cbranch_vccnz L_spind_pq7
    s_sleep 1
    s_sub_u32 s100, s100, 1
    s_cbranch_scc0 L_spin_pq7
L_spind_pq7:
    s_branch L_ypsd_7
L_ypw_11:
    s_call_b64 s[44:45], L_yp_poll
    s_branch L_ypwd_11
L_ypw_12:
    s_call_b64 s[44:45], L_yp_poll
    s_branch L_ypwd_12
L_yps_9:
    s_mov_b32 s100, 4194304
L_spin_pq9:
    ds_read_b32 v6, v254
    s_waitcnt lgkmcnt(0)
    v_cmp_le_u32 vcc, s48, v6
    s_cbranch_vccnz L_spind_pq9
    s_sleep 1
    s_sub_u32 s100, s100, 1
    s_cbranch_scc0 L_spin_pq9
L_spind_pq9:
    s_branch L_ypsd_9
L_ypw_13:
    s_call_b64 s[44:45], L_yp_poll
    s_branch L_ypwd_13
L_ypw_14:
    s_call_b64 s[44:45], L_yp_poll
    s_branch L_ypwd_14
L_yps_11:
    s_mov_b32 s100, 4194304
L_spin_pq11:
    ds_read_b32 v6, v254
    s_waitcnt lgkmcnt(0)
    v_cmp_le_u32 vcc, s48, v6
    s_cbranch_vccnz L_spind_pq11
    s_sleep 1
    s_sub_u32 s100, s100, 1
    s_cbranch_scc0 L_spin_pq11
L_spind_pq11:
    s_branch L_ypsd_11
L_ypw_15:
    s_call_b64 s[44:45], L_yp_poll
    s_branch L_ypwd_15
L_yps_13:
    s_mov_b32 s100, 4194304
L_spin_pq13:
    ds_read_b32 v6, v254
    s_waitcnt lgkmcnt(0)
    v_cmp_le_u32 vcc, s48, v6
    s_cbranch_vccnz L_spind_pq13
    s_sleep 1
    s_sub_u32 s100, s100, 1
    s_cbranch_scc0 L_spin_pq13
L_spind_pq13:
    s_branch L_ypsd_13
L_yps_15:
    s_mov_b32 s100, 4194304
L_spin_pq15:
    ds_read_b32 v6, v254
    s_waitcnt lgkmcnt(0)
    v_cmp_le_u32 vcc, s48, v6
    s_cbranch_vccnz L_spind_pq15
    s_sleep 1
    s_sub_u32 s100, s100, 1
    s_cbranch_scc0 L_spin_pq15
L_spind_pq15:
    s_branch L_ypsd_15
L_ypw_16:
    s_call_b64 s[44:45], L_yp_poll
    s_branch L_ypwd_16
L_ypw_17:
    s_call_b64 s[44:45], L_yp_poll
    s_branch L_ypwd_17
L_ypw_18:
    s_call_b64 s[44:45], L_yp_poll
    s_branch L_ypwd_18
L_ypw_19:
    s_call_b64 s[44:45], L_yp_poll
    s_branch L_ypwd_19
L_ypw_20:
    s_call_b64 s[44:45], L_yp_poll
    s_branch L_ypwd_20
L_ypw_21:
    s_call_b64 s[44:45], L_yp_poll
    s_branch L_ypwd_21
L_ypw_22:
    s_call_b64 s[44:45], L_yp_poll
    s_branch L_ypwd_22
L_yps_19:
    s_mov_b32 s100, 4194304
L_spin_pq19:
    ds_read_b32 v6, v254
    s_waitcnt lgkmcnt(0)
    v_cmp_le_u32 vcc, s48, v6
    s_cbranch_vccnz L_spind_pq19
    s_sleep 1
    s_sub_u32 s100, s100, 1
    s_cbranch_scc0 L_spin_pq19
L_spind_pq19:
    s_branch L_ypsd_19
L_ypw_23:
    s_call_b64 s[44:45], L_yp_poll
    s_branch L_ypwd_23
L_ypw_24:
    s_call_b64 s[44:45], L_yp_poll
    s_branch L_ypwd_24
L_yps_21:
    s_mov_b32 s100, 4194304
L_spin_pq21:
    ds_read_b32 v6, v254
    s_waitcnt lgkmcnt(0)
    v_cmp_le_u32 vcc, s48, v6
    s_cbranch_vccnz L_spind_pq21
    s_sleep 1
    s_sub_u32 s100, s100, 1
    s_cbranch_scc0 L_spin_pq21
L_spind_pq21:
    s_branch L_ypsd_21
L_ypw_25:
    s_call_b64 s[44:45], L_yp_poll
    s_branch L_ypwd_25
L_ypw_26:
    s_call_b64 s[44:45], L_yp_poll
    s_branch L_ypwd_26
L_yps_23:
    s_mov_b32 s100, 4194304
L_spin_pq23:
    ds_read_b32 v6, v254
    s_waitcnt lgkmcnt(0)
    v_cmp_le_u32 vcc, s48, v6
    s_cbranch_vccnz L_spind_pq23
    s_sleep 1
    s_sub_u32 s100, s100, 1
    s_cbranch_scc0 L_spin_pq23
L_spind_pq23:
    s_branch L_ypsd_23
L_ypw_27:
    s_call_b64 s[44:45], L_yp_poll
    s_branch L_ypwd_27
L_ypw_28:
    s_call_b64 s[44:45], L_yp_poll
    s_branch L_ypwd_28
L_yps_25:
    s_mov_b32 s100, 4194304
L_spin_pq25:
    ds_read_b32 v6, v254
    s_waitcnt lgkmcnt(0)
    v_cmp_le_u32 vcc, s48, v6
    s_cbranch_vccnz L_spind_pq25
    s_sleep 1
    s_sub_u32 s100, s100, 1
    s_cbranch_scc0 L_spin_pq25
L_spind_pq25:
    s_branch L_ypsd_25
L_ypw_29:
    s_call_b64 s[44:45], L_yp_poll
    s_branch L_ypwd_29
L_ypw_30:
    s_call_b64 s[44:45], L_yp_poll
    s_branch L_ypwd_30
L_yps_27:
    s_mov_b32 s100, 4194304
L_spin_pq27:
    ds_read_b32 v6, v254
    s_waitcnt lgkmcnt(0)
    v_cmp_le_u32 vcc, s48, v6
    s_cbranch_vccnz L_spind_pq27
    s_sleep 1
    s_sub_u32 s100, s100, 1
    s_cbranch_scc0 L_spin_pq27
L_spind_pq27:
    s_branch L_ypsd_27
L_ypw_31:
    s_call_b64 s[44:45], L_yp_poll
    s_branch L_ypwd_31
L_non_x:
    s_mov_b32 s100, 262144
L_nonl_x:
    v_mov_b32 v6, 0
    global_load_dwordx4 v[12:15], v6, s[18:19] sc1
    s_waitcnt vmcnt(0)
    v_readfirstlane_b32 s62, v12
    v_readfirstlane_b32 s63, v13
    v_cmp_ne_u32 vcc, 0, v14
    s_cbranch_vccnz L_nond_x
    s_sleep 8
    s_sub_u32 s100, s100, 1
    s_cbranch_scc0 L_nonl_x
    s_branch L_nond_x
L_xw_p0:
    s_lshl_b32 s51, 1, s50
    s_mov_b32 s100, 262144
L_poll_xp0:
    v_lshlrev_b32 v2, 3, v1
    s_mov_b64 exec, 0xffff
    buffer_load_dwordx2 v[2:3], v2, s[12:15], s49 offen sc1
    s_waitcnt vmcnt(0)
    v_cmp_eq_u64 vcc, s[62:63], v[2:3]
    s_mov_b64 exec, -1
    s_nop 3
    s_or_b32 s56, s56, vcc_lo
    s_and_b32 s101, s56, s51
    s_cmp_eq_u32 s101, s51
    s_cbranch_scc1 L_polld_xp0
    s_sleep 4
    s_sub_u32 s100, s100, 1
    s_cbranch_scc0 L_poll_xp0
L_polld_xp0:
    s_branch L_xwd_p0
L_xw_p4:
    s_lshl_b32 s51, 1, s50
    s_mov_b32 s100, 262144
L_poll_xp4:
    v_lshlrev_b32 v2, 3, v1
    s_mov_b64 exec, 0xffff
    buffer_load_dwordx2 v[2:3], v2, s[12:15], s49 offen sc1
    s_waitcnt vmcnt(0)
    v_cmp_eq_u64 vcc, s[62:63], v[2:3]
    s_mov_b64 exec, -1
    s_nop 3
    s_or_b32 s56, s56, vcc_lo
    s_and_b32 s101, s56, s51
    s_cmp_eq_u32 s101, s51
    s_cbranch_scc1 L_polld_xp4
    s_sleep 4
    s_sub_u32 s100, s100, 1
    s_cbranch_scc0 L_poll_xp4
L_polld_xp4:
    s_branch L_xwd_p4
L_xw_p8:
    s_lshl_b32 s51, 1, s50
    s_mov_b32 s100, 262144
L_poll_xp8:
    v_lshlrev_b32 v2, 3, v1
    s_mov_b64 exec, 0xffff
    buffer_load_dwordx2 v[2:3], v2, s[12:15], s49 offen sc1
    s_waitcnt vmcnt(0)
    v_cmp_eq_u64 vcc, s[62:63], v[2:3]
    s_mov_b64 exec, -1
    s_nop 3
    s_or_b32 s56, s56, vcc_lo
    s_and_b32 s101, s56, s51
    s_cmp_eq_u32 s101, s51
    s_cbranch_scc1 L_polld_xp8
    s_sleep 4
    s_sub_u32 s100, s100, 1
    s_cbranch_scc0 L_poll_xp8
L_polld_xp8:
    s_branch L_xwd_p8
L_xw_b0:
    s_lshl_b32 s51, 1, s50
    s_mov_b32 s100, 262144
L_poll_xb0:
    v_lshlrev_b32 v2, 3, v1
    s_mov_b64 exec, 0xffff
    buffer_load_dwordx2 v[2:3], v2, s[12:15], s49 offen sc1
    s_waitcnt vmcnt(0)
    v_cmp_eq_u64 vcc, s[62:63], v[2:3]
    s_mov_b64 exec, -1
    s_nop 3
    s_or_b32 s56, s56, vcc_lo
    s_and_b32 s101, s56, s51
    s_cmp_eq_u32 s101, s51
    s_cbranch_scc1 L_polld_xb0
    s_sleep 4
    s_sub_u32 s100, s100, 1
    s_cbranch_scc0 L_poll_xb0
L_polld_xb0:
    s_branch L_xwd_b0
L_xw_b1:
    s_lshl_b32 s51, 1, s50
    s_mov_b32 s100, 262144
L_poll_xb1:
    v_lshlrev_b32 v2, 3, v1
    s_mov_b64 exec, 0xffff
    buffer_load_dwordx2 v[2:3], v2, s[12:15], s49 offen sc1
    s_waitcnt vmcnt(0)
    v_cmp_eq_u64 vcc, s[62:63], v[2:3]
    s_mov_b64 exec, -1
    s_nop 3
    s_or_b32 s56, s56, vcc_lo
    s_and_b32 s101, s56, s51
    s_cmp_eq_u32 s101, s51
    s_cbranch_scc1 L_polld_xb1
    s_sleep 4
    s_sub_u32 s100, s100, 1
    s_cbranch_scc0 L_poll_xb1
L_polld_xb1:
    s_branch L_xwd_b1
L_xw_b2:
    s_lshl_b32 s51, 1, s50
    s_mov_b32 s100, 262144
L_poll_xb2:
    v_lshlrev_b32 v2, 3, v1
    s_mov_b64 exec, 0xffff
    buffer_load_dwordx2 v[2:3], v2, s[12:15], s49 offen sc1
    s_waitcnt vmcnt(0)
    v_cmp_eq_u64 vcc, s[62:63], v[2:3]
    s_mov_b64 exec, -1
    s_nop 3
    s_or_b32 s56, s56, vcc_lo
    s_and_b32 s101, s56, s51
    s_cmp_eq_u32 s101, s51
    s_cbranch_scc1 L_polld_xb2
    s_sleep 4
    s_sub_u32 s100, s100, 1
    s_cbranch_scc0 L_poll_xb2
L_polld_xb2:
    s_branch L_xwd_b2
L_xw_b3:
    s_lshl_b32 s51, 1, s50
    s_mov_b32 s100, 262144
L_poll_xb3:
    v_lshlrev_b32 v2, 3, v1
    s_mov_b64 exec, 0xffff
    buffer_load_dwordx2 v[2:3], v2, s[12:15], s49 offen sc1
    s_waitcnt vmcnt(0)
    v_cmp_eq_u64 vcc, s[62:63], v[2:3]
    s_mov_b64 exec, -1
    s_nop 3
    s_or_b32 s56, s56, vcc_lo
    s_and_b32 s101, s56, s51
    s_cmp_eq_u32 s101, s51
    s_cbranch_scc1 L_polld_xb3
    s_sleep 4
    s_sub_u32 s100, s100, 1
    s_cbranch_scc0 L_poll_xb3
L_polld_xb3:
    s_branch L_xwd_b3
L_xw_b4:
    s_lshl_b32 s51, 1, s50
    s_mov_b32 s100, 262144
L_poll_xb4:
    v_lshlrev_b32 v2, 3, v1
    s_mov_b64 exec, 0xffff
    buffer_load_dwordx2 v[2:3], v2, s[12:15], s49 offen sc1
    s_waitcnt vmcnt(0)
    v_cmp_eq_u64 vcc, s[62:63], v[2:3]
    s_mov_b64 exec, -1
    s_nop 3
    s_or_b32 s56, s56, vcc_lo
    s_and_b32 s101, s56, s51
    s_cmp_eq_u32 s101, s51
    s_cbranch_scc1 L_polld_xb4
    s_sleep 4
    s_sub_u32 s100, s100, 1
    s_cbranch_scc0 L_poll_xb4
L_polld_xb4:
    s_branch L_xwd_b4
L_xslow0:
    s_mov_b32 s54, s38
    s_mov_b32 s55, 64
    s_mov_b32 s57, 0
    v_mov_b32 v176, v160
    v_mov_b32 v177, v161
    v_mov_b32 v178, v162
    v_mov_b32 v179, v163
    v_mov_b32 v180, v164
    v_mov_b32 v181, v165
    v_mov_b32 v182, v166
    v_mov_b32 v183, v167
    s_call_b64 s[52:53], L_slow
    v_rcp_f32 v3, v228
    s_nop 0
    v_mul_f32 v48, v3, v80
    v_mul_f32 v49, v3, v81
    v_mul_f32 v50, v3, v82
    v_mul_f32 v51, v3, v83
    v_mul_f32 v52, v3, v84
    v_mul_f32 v53, v3, v85
    v_mul_f32 v54, v3, v86
    v_mul_f32 v55, v3, v87
    v_mul_f32 v56, v3, v88
    v_mul_f32 v57, v3, v89
    v_mul_f32 v58, v3, v90
    v_mul_f32 v59, v3, v91
    v_mul_f32 v60, v3, v92
    v_mul_f32 v61, v3, v93
    v_mul_f32 v62, v3, v94
    v_mul_f32 v63, v3, v95
    s_branch L_xslowd0
L_xslow1:
    s_mov_b32 s54, s38
    s_mov_b32 s55, 64
    s_mov_b32 s57, 0
    v_mov_b32 v176, v168
    v_mov_b32 v177, v169
    v_mov_b32 v178, v170
    v_mov_b32 v179, v171
    v_mov_b32 v180, v172
    v_mov_b32 v181, v173
    v_mov_b32 v182, v174
    v_mov_b32 v183, v175
    s_call_b64 s[52:53], L_slow
    v_rcp_f32 v3, v228
    s_nop 0
    v_mul_f32 v64, v3, v80
    v_mul_f32 v65, v3, v81
    v_mul_f32 v66, v3, v82
    v_mul_f32 v67, v3, v83
    v_mul_f32 v68, v3, v84
    v_mul_f32 v69, v3, v85
    v_mul_f32 v70, v3, v86
    v_mul_f32 v71, v3, v87
    v_mul_f32 v72, v3, v88
    v_mul_f32 v73, v3, v89
    v_mul_f32 v74, v3, v90
    v_mul_f32 v75, v3, v91
    v_mul_f32 v76, v3, v92
    v_mul_f32 v77, v3, v93
    v_mul_f32 v78, v3, v94
    v_mul_f32 v79, v3, v95
    s_branch L_xslowd1
L_a_inv0:
    s_nop 7
    v_mov_b32 v112, v5
    v_mov_b32 v113, v5
    v_mov_b32 v114, v5
    v_mov_b32 v115, v5
    v_mov_b32 v116, v5
    v_mov_b32 v117, v5
    v_mov_b32 v118, v5
    v_mov_b32 v119, v5
    v_mov_b32 v120, v5
    v_mov_b32 v121, v5
    v_mov_b32 v122, v5
    v_mov_b32 v123, v5
    v_mov_b32 v124, v5
    v_mov_b32 v125, v5
    v_mov_b32 v126, v5
    v_mov_b32 v127, v5
    s_nop 1
    s_branch L_a_val0
L_a_inv1:
    s_nop 7
    v_mov_b32 v112, v5
    v_mov_b32 v113, v5
    v_mov_b32 v114, v5
    v_mov_b32 v115, v5
    v_mov_b32 v116, v5
    v_mov_b32 v117, v5
    v_mov_b32 v118, v5
    v_mov_b32 v119, v5
    v_mov_b32 v120, v5
    v_mov_b32 v121, v5
    v_mov_b32 v122, v5
    v_mov_b32 v123, v5
    v_mov_b32 v124, v5
    v_mov_b32 v125, v5
    v_mov_b32 v126, v5
    v_mov_b32 v127, v5
    s_nop 1
    s_branch L_a_val1
L_a_inv2:
    s_nop 7
    v_mov_b32 v112, v5
    v_mov_b32 v113, v5
    v_mov_b32 v114, v5
    v_mov_b32 v115, v5
    v_mov_b32 v116, v5
    v_mov_b32 v117, v5
    v_mov_b32 v118, v5
    v_mov_b32 v119, v5
    v_mov_b32 v120, v5
    v_mov_b32 v121, v5
    v_mov_b32 v122, v5
    v_mov_b32 v123, v5
    v_mov_b32 v124, v5
    v_mov_b32 v125, v5
    v_mov_b32 v126, v5
    v_mov_b32 v127, v5
    s_nop 1
    s_branch L_a_val2
L_a_inv3:
    s_nop 7
    v_mov_b32 v112, v5
    v_mov_b32 v113, v5
    v_mov_b32 v114, v5
    v_mov_b32 v115, v5
    v_mov_b32 v116, v5
    v_mov_b32 v117, v5
    v_mov_b32 v118, v5
    v_mov_b32 v119, v5
    v_mov_b32 v120, v5
    v_mov_b32 v121, v5
    v_mov_b32 v122, v5
    v_mov_b32 v123, v5
    v_mov_b32 v124, v5
    v_mov_b32 v125, v5
    v_mov_b32 v126, v5
    v_mov_b32 v127, v5
    s_nop 1
    s_branch L_a_val3
L_a_inv4:
    s_nop 7
    v_mov_b32 v112, v5
    v_mov_b32 v113, v5
    v_mov_b32 v114, v5
    v_mov_b32 v115, v5
    v_mov_b32 v116, v5
    v_mov_b32 v117, v5
    v_mov_b32 v118, v5
    v_mov_b32 v119, v5
    v_mov_b32 v120, v5
    v_mov_b32 v121, v5
    v_mov_b32 v122, v5
    v_mov_b32 v123, v5
    v_mov_b32 v124, v5
    v_mov_b32 v125, v5
    v_mov_b32 v126, v5
    v_mov_b32 v127, v5
    s_nop 1
    s_branch L_a_val4
L_a_inv5:
    s_nop 7
    v_mov_b32 v112, v5
    v_mov_b32 v113, v5
    v_mov_b32 v114, v5
    v_mov_b32 v115, v5
    v_mov_b32 v116, v5
    v_mov_b32 v117, v5
    v_mov_b32 v118, v5
    v_mov_b32 v119, v5
    v_mov_b32 v120, v5
    v_mov_b32 v121, v5
    v_mov_b32 v122, v5
    v_mov_b32 v123, v5
    v_mov_b32 v124, v5
    v_mov_b32 v125, v5
    v_mov_b32 v126, v5
    v_mov_b32 v127, v5
    s_nop 1
    s_branch L_a_val5
L_a_inv6:
    s_nop 7
    v_mov_b32 v112, v5
    v_mov_b32 v113, v5
    v_mov_b32 v114, v5
    v_mov_b32 v115, v5
    v_mov_b32 v116, v5
    v_mov_b32 v117, v5
    v_mov_b32 v118, v5
    v_mov_b32 v119, v5
    v_mov_b32 v120, v5
    v_mov_b32 v121, v5
    v_mov_b32 v122, v5
    v_mov_b32 v123, v5
    v_mov_b32 v124, v5
    v_mov_b32 v125, v5
    v_mov_b32 v126, v5
    v_mov_b32 v127, v5
    s_nop 1
    s_branch L_a_val6
L_a_inv7:
    s_nop 7
    v_mov_b32 v112, v5
    v_mov_b32 v113, v5
    v_mov_b32 v114, v5
    v_mov_b32 v115, v5
    v_mov_b32 v116, v5
    v_mov_b32 v117, v5
    v_mov_b32 v118, v5
    v_mov_b32 v119, v5
    v_mov_b32 v120, v5
    v_mov_b32 v121, v5
    v_mov_b32 v122, v5
    v_mov_b32 v123, v5
    v_mov_b32 v124, v5
    v_mov_b32 v125, v5
    v_mov_b32 v126, v5
    v_mov_b32 v127, v5
    s_nop 1
    s_branch L_a_val7
L_resc_a2:
    s_nop 15
    v_frexp_exp_i32_f32 v2, v228
    v_add_u32 v2, 88, v2
    v_cvt_f32_i32 v3, v2
    v_sub_u32 v2, 0, v2
    v_ldexp_f32 v80, v80, v2
    v_ldexp_f32 v81, v81, v2
    v_ldexp_f32 v82, v82, v2
    v_ldexp_f32 v83, v83, v2
    v_ldexp_f32 v84, v84, v2
    v_ldexp_f32 v85, v85, v2
    v_ldexp_f32 v86, v86, v2
    v_ldexp_f32 v87, v87, v2
    v_ldexp_f32 v88, v88, v2
    v_ldexp_f32 v89, v89, v2
    v_ldexp_f32 v90, v90, v2
    v_ldexp_f32 v91, v91, v2
    v_ldexp_f32 v92, v92, v2
    v_ldexp_f32 v93, v93, v2
    v_ldexp_f32 v94, v94, v2
    v_ldexp_f32 v95, v95, v2
    v_ldexp_f32 v228, v228, v2
    v_sub_f32 v112, v112, v3
    v_sub_f32 v113, v113, v3
    v_sub_f32 v114, v114, v3
    v_sub_f32 v115, v115, v3
    v_sub_f32 v116, v116, v3
    v_sub_f32 v117, v117, v3
    v_sub_f32 v118, v118, v3
    v_sub_f32 v119, v119, v3
    v_sub_f32 v120, v120, v3
    v_sub_f32 v121, v121, v3
    v_sub_f32 v122, v122, v3
    v_sub_f32 v123, v123, v3
    v_sub_f32 v124, v124, v3
    v_sub_f32 v125, v125, v3
    v_sub_f32 v126, v126, v3
    v_sub_f32 v127, v127, v3
    v_ldexp_f32 v24, v24, v2
    v_ldexp_f32 v25, v25, v2
    v_ldexp_f32 v26, v26, v2
    v_ldexp_f32 v27, v27, v2
    v_ldexp_f32 v28, v28, v2
    v_ldexp_f32 v29, v29, v2
    v_ldexp_f32 v30, v30, v2
    v_sub_f32 v31, v31, v3
    v_sub_f32 v32, v32, v3
    v_sub_f32 v33, v33, v3
    v_sub_f32 v34, v34, v3
    v_sub_f32 v35, v35, v3
    v_sub_f32 v36, v36, v3
    v_sub_f32 v37, v37, v3
    v_sub_f32 v38, v38, v3
    v_sub_f32 v39, v39, v3
    v_sub_f32 v40, v40, v3
    v_sub_f32 v41, v41, v3
    v_sub_f32 v42, v42, v3
    v_sub_f32 v43, v43, v3
    v_sub_f32 v44, v44, v3
    v_sub_f32 v45, v45, v3
    v_sub_f32 v46, v46, v3
    v_sub_f32 v47, v47, v3
    s_nop 1
    s_branch L_back_a2
L_resc_a5:
    s_nop 15
    v_frexp_exp_i32_f32 v2, v228
    v_add_u32 v2, 88, v2
    v_cvt_f32_i32 v3, v2
    v_sub_u32 v2, 0, v2
    v_ldexp_f32 v80, v80, v2
    v_ldexp_f32 v81, v81, v2
    v_ldexp_f32 v82, v82, v2
    v_ldexp_f32 v83, v83, v2
    v_ldexp_f32 v84, v84, v2
    v_ldexp_f32 v85, v85, v2
    v_ldexp_f32 v86, v86, v2
    v_ldexp_f32 v87, v87, v2
    v_ldexp_f32 v88, v88, v2
    v_ldexp_f32 v89, v89, v2
    v_ldexp_f32 v90, v90, v2
    v_ldexp_f32 v91, v91, v2
    v_ldexp_f32 v92, v92, v2
    v_ldexp_f32 v93, v93, v2
    v_ldexp_f32 v94, v94, v2
    v_ldexp_f32 v95, v95, v2
    v_ldexp_f32 v228, v228, v2
    v_sub_f32 v112, v112, v3
    v_sub_f32 v113, v113, v3
    v_sub_f32 v114, v114, v3
    v_sub_f32 v115, v115, v3
    v_sub_f32 v116, v116, v3
    v_sub_f32 v117, v117, v3
    v_sub_f32 v118, v118, v3
    v_sub_f32 v119, v119, v3
    v_sub_f32 v120, v120, v3
    v_sub_f32 v121, v121, v3
    v_sub_f32 v122, v122, v3
    v_sub_f32 v123, v123, v3
    v_sub_f32 v124, v124, v3
    v_sub_f32 v125, v125, v3
    v_sub_f32 v126, v126, v3
    v_sub_f32 v127, v127, v3
    v_ldexp_f32 v40, v40, v2
    v_ldexp_f32 v41, v41, v2
    v_ldexp_f32 v42, v42, v2
    v_ldexp_f32 v43, v43, v2
    v_ldexp_f32 v44, v44, v2
    v_ldexp_f32 v45, v45, v2
    v_ldexp_f32 v46, v46, v2
    v_sub_f32 v47, v47, v3
    v_sub_f32 v16, v16, v3
    v_sub_f32 v17, v17, v3
    v_sub_f32 v18, v18, v3
    v_sub_f32 v19, v19, v3
    v_sub_f32 v20, v20, v3
    v_sub_f32 v21, v21, v3
    v_sub_f32 v22, v22, v3
    v_sub_f32 v23, v23, v3
    v_sub_f32 v24, v24, v3
    v_sub_f32 v25, v25, v3
    v_sub_f32 v26, v26, v3
    v_sub_f32 v27, v27, v3
    v_sub_f32 v28, v28, v3
    v_sub_f32 v29, v29, v3
    v_sub_f32 v30, v30, v3
    v_sub_f32 v31, v31, v3
    s_nop 1
    s_branch L_back_a5
L_resc_x1:
    s_call_b64 s[52:53], L_rescx
    s_branch L_back_x1
L_resc_x3:
    s_call_b64 s[52:53], L_rescx
    s_branch L_back_x3
L_rescx:
    s_nop 15
    v_frexp_exp_i32_f32 v2, v12
    v_add_u32 v2, 88, v2
    v_cvt_f32_i32 v3, v2
    v_sub_u32 v2, 0, v2
    v_ldexp_f32 v48, v48, v2
    v_ldexp_f32 v49, v49, v2
    v_ldexp_f32 v50, v50, v2
    v_ldexp_f32 v51, v51, v2
    v_ldexp_f32 v52, v52, v2
    v_ldexp_f32 v53, v53, v2
    v_ldexp_f32 v54, v54, v2
    v_ldexp_f32 v55, v55, v2
    v_ldexp_f32 v56, v56, v2
    v_ldexp_f32 v57, v57, v2
    v_ldexp_f32 v58, v58, v2
    v_ldexp_f32 v59, v59, v2
    v_ldexp_f32 v60, v60, v2
    v_ldexp_f32 v61, v61, v2
    v_ldexp_f32 v62, v62, v2
    v_ldexp_f32 v63, v63, v2
    v_ldexp_f32 v12, v12, v2
    v_sub_f32 v112, v112, v3
    v_sub_f32 v113, v113, v3
    v_sub_f32 v114, v114, v3
    v_sub_f32 v115, v115, v3
    v_sub_f32 v116, v116, v3
    v_sub_f32 v117, v117, v3
    v_sub_f32 v118, v118, v3
    v_sub_f32 v119, v119, v3
    v_sub_f32 v120, v120, v3
    v_sub_f32 v121, v121, v3
    v_sub_f32 v122, v122, v3
    v_sub_f32 v123, v123, v3
    v_sub_f32 v124, v124, v3
    v_sub_f32 v125, v125, v3
    v_sub_f32 v126, v126, v3
    v_sub_f32 v127, v127, v3
    v_sub_f32 v16, v16, v3
    v_sub_f32 v17, v17, v3
    v_sub_f32 v18, v18, v3
    v_sub_f32 v19, v19, v3
    v_sub_f32 v20, v20, v3
    v_sub_f32 v21, v21, v3
    v_sub_f32 v22, v22, v3
    v_sub_f32 v23, v23, v3
    v_sub_f32 v24, v24, v3
    v_sub_f32 v25, v25, v3
    v_sub_f32 v26, v26, v3
    v_sub_f32 v27, v27, v3
    v_sub_f32 v28, v28, v3
    v_sub_f32 v29, v29, v3
    v_sub_f32 v30, v30, v3
    v_sub_f32 v31, v31, v3
    v_frexp_exp_i32_f32 v2, v248
    v_add_u32 v2, 88, v2
    v_cvt_f32_i32 v3, v2
    v_sub_u32 v2, 0, v2
    v_ldexp_f32 v64, v64, v2
    v_ldexp_f32 v65, v65, v2
    v_ldexp_f32 v66, v66, v2
    v_ldexp_f32 v67, v67, v2
    v_ldexp_f32 v68, v68, v2
    v_ldexp_f32 v69, v69, v2
    v_ldexp_f32 v70, v70, v2
    v_ldexp_f32 v71, v71, v2
    v_ldexp_f32 v72, v72, v2
    v_ldexp_f32 v73, v73, v2
    v_ldexp_f32 v74, v74, v2
    v_ldexp_f32 v75, v75, v2
    v_ldexp_f32 v76, v76, v2
    v_ldexp_f32 v77, v77, v2
    v_ldexp_f32 v78, v78, v2
    v_ldexp_f32 v79, v79, v2
    v_ldexp_f32 v248, v248, v2
    v_sub_f32 v128, v128, v3
    v_sub_f32 v129, v129, v3
    v_sub_f32 v130, v130, v3
    v_sub_f32 v131, v131, v3
    v_sub_f32 v132, v132, v3
    v_sub_f32 v133, v133, v3
    v_sub_f32 v134, v134, v3
    v_sub_f32 v135, v135, v3
    v_sub_f32 v136, v136, v3
    v_sub_f32 v137, v137, v3
    v_sub_f32 v138, v138, v3
    v_sub_f32 v139, v139, v3
    v_sub_f32 v140, v140, v3
    v_sub_f32 v141, v141, v3
    v_sub_f32 v142, v142, v3
    v_sub_f32 v143, v143, v3
    v_frexp_exp_i32_f32 v2, v250
    v_add_u32 v2, 88, v2
    v_cvt_f32_i32 v3, v2
    v_sub_u32 v2, 0, v2
    v_ldexp_f32 v80, v80, v2
    v_ldexp_f32 v81, v81, v2
    v_ldexp_f32 v82, v82, v2
    v_ldexp_f32 v83, v83, v2
    v_ldexp_f32 v84, v84, v2
    v_ldexp_f32 v85, v85, v2
    v_ldexp_f32 v86, v86, v2
    v_ldexp_f32 v87, v87, v2
    v_ldexp_f32 v88, v88, v2
    v_ldexp_f32 v89, v89, v2
    v_ldexp_f32 v90, v90, v2
    v_ldexp_f32 v91, v91, v2
    v_ldexp_f32 v92, v92, v2
    v_ldexp_f32 v93, v93, v2
    v_ldexp_f32 v94, v94, v2
    v_ldexp_f32 v95, v95, v2
    v_ldexp_f32 v250, v250, v2
    v_sub_f32 v144, v144, v3
    v_sub_f32 v145, v145, v3
    v_sub_f32 v146, v146, v3
    v_sub_f32 v147, v147, v3
    v_sub_f32 v148, v148, v3
    v_sub_f32 v149, v149, v3
    v_sub_f32 v150, v150, v3
    v_sub_f32 v151, v151, v3
    v_sub_f32 v152, v152, v3
    v_sub_f32 v153, v153, v3
    v_sub_f32 v154, v154, v3
    v_sub_f32 v155, v155, v3
    v_sub_f32 v156, v156, v3
    v_sub_f32 v157, v157, v3
    v_sub_f32 v158, v158, v3
    v_sub_f32 v159, v159, v3
    v_frexp_exp_i32_f32 v2, v252
    v_add_u32 v2, 88, v2
    v_cvt_f32_i32 v3, v2
    v_sub_u32 v2, 0, v2
    v_ldexp_f32 v96, v96, v2
    v_ldexp_f32 v97, v97, v2
    v_ldexp_f32 v98, v98, v2
    v_ldexp_f32 v99, v99, v2
    v_ldexp_f32 v100, v100, v2
    v_ldexp_f32 v101, v101, v2
    v_ldexp_f32 v102, v102, v2
    v_ldexp_f32 v103, v103, v2
    v_ldexp_f32 v104, v104, v2
    v_ldexp_f32 v105, v105, v2
    v_ldexp_f32 v106, v106, v2
    v_ldexp_f32 v107, v107, v2
    v_ldexp_f32 v108, v108, v2
    v_ldexp_f32 v109, v109, v2
    v_ldexp_f32 v110, v110, v2
    v_ldexp_f32 v111, v111, v2
    v_ldexp_f32 v252, v252, v2
    v_sub_f32 v232, v232, v3
    v_sub_f32 v233, v233, v3
    v_sub_f32 v234, v234, v3
    v_sub_f32 v235, v235, v3
    v_sub_f32 v236, v236, v3
    v_sub_f32 v237, v237, v3
    v_sub_f32 v238, v238, v3
    v_sub_f32 v239, v239, v3
    v_sub_f32 v240, v240, v3
    v_sub_f32 v241, v241, v3
    v_sub_f32 v242, v242, v3
    v_sub_f32 v243, v243, v3
    v_sub_f32 v244, v244, v3
    v_sub_f32 v245, v245, v3
    v_sub_f32 v246, v246, v3
    v_sub_f32 v247, v247, v3
    v_ldexp_f32 v40, v40, v2
    v_ldexp_f32 v41, v41, v2
    v_ldexp_f32 v42, v42, v2
    v_ldexp_f32 v43, v43, v2
    v_ldexp_f32 v44, v44, v2
    v_ldexp_f32 v45, v45, v2
    v_ldexp_f32 v46, v46, v2
    v_sub_f32 v47, v47, v3
    s_nop 1
    s_setpc_b64 s[52:53]
L_slow:
    s_waitcnt vmcnt(0)
    s_nop 15
    v_mov_b32 v32, 0xff7fffff
    s_mov_b32 s50, 0
    v_mov_b32 v80, 0
    v_mov_b32 v81, 0
    v_mov_b32 v82, 0
    v_mov_b32 v83, 0
    v_mov_b32 v84, 0
    v_mov_b32 v85, 0
    v_mov_b32 v86, 0
    v_mov_b32 v87, 0
    v_mov_b32 v88, 0
    v_mov_b32 v89, 0
    v_mov_b32 v90, 0
    v_mov_b32 v91, 0
    v_mov_b32 v92, 0
    v_mov_b32 v93, 0
    v_mov_b32 v94, 0
    v_mov_b32 v95, 0
    v_mov_b32 v228, 0
    v_mov_b32 v229, 0
    v_mov_b32 v230, 0
    v_mov_b32 v231, 0
L_slow_loop:
    buffer_load_dwordx4 v[192:195], v1, s[12:15], s54 offen offset:0 sc1
    buffer_load_dwordx4 v[196:199], v1, s[12:15], s54 offen offset:1024 sc1
    buffer_load_dwordx4 v[200:203], v1, s[12:15], s54 offen offset:2048 sc1
    buffer_load_dwordx4 v[204:207], v1, s[12:15], s54 offen offset:3072 sc1
    s_waitcnt vmcnt(0)
    v_mfma_f32_32x32x16_bf16 v[16:31], v[192:195], v[176:179], 0
    v_mfma_f32_32x32x16_bf16 v[16:31], v[196:199], v[180:183], v[16:31]
    s_nop 15
    s_cmp_eq_u32 s57, 1
    s_cbranch_scc0 L_slow_nm1
    s_cmp_eq_u32 s50, 0
    s_cbranch_scc0 L_slow_nm1
    v_cndmask_b32 v16, v5, v16, s[64:65]
    v_cndmask_b32 v17, v5, v17, s[66:67]
    v_cndmask_b32 v18, v5, v18, s[68:69]
    v_cndmask_b32 v19, v5, v19, s[70:71]
    v_cndmask_b32 v20, v5, v20, s[72:73]
    v_cndmask_b32 v21, v5, v21, s[74:75]
    v_cndmask_b32 v22, v5, v22, s[76:77]
    v_cndmask_b32 v23, v5, v23, s[78:79]
    v_cndmask_b32 v24, v5, v24, s[80:81]
    v_cndmask_b32 v25, v5, v25, s[82:83]
    v_cndmask_b32 v26, v5, v26, s[84:85]
    v_cndmask_b32 v27, v5, v27, s[86:87]
    v_cndmask_b32 v28, v5, v28, s[88:89]
    v_cndmask_b32 v29, v5, v29, s[90:91]
    v_cndmask_b32 v30, v5, v30, s[92:93]
    v_cndmask_b32 v31, v5, v31, s[94:95]
L_slow_nm1:
    s_add_u32 s50, s50, 1
    s_cmp_eq_u32 s57, 0
    s_cbranch_scc1 L_slow_nm2
    s_cmp_eq_u32 s50, s55
    s_cbranch_scc0 L_slow_nm2
    v_cndmask_b32 v16, v16, v5, s[64:65]
    v_cndmask_b32 v17, v17, v5, s[66:67]
    v_cndmask_b32 v18, v18, v5, s[68:69]
    v_cndmask_b32 v19, v19, v5, s[70:71]
    v_cndmask_b32 v20, v20, v5, s[72:73]
    v_cndmask_b32 v21, v21, v5, s[74:75]
    v_cndmask_b32 v22, v22, v5, s[76:77]
    v_cndmask_b32 v23, v23, v5, s[78:79]
    v_cndmask_b32 v24, v24, v5, s[80:81]
    v_cndmask_b32 v25, v25, v5, s[82:83]
    v_cndmask_b32 v26, v26, v5, s[84:85]
    v_cndmask_b32 v27, v27, v5, s[86:87]
    v_cndmask_b32 v28, v28, v5, s[88:89]
    v_cndmask_b32 v29, v29, v5, s[90:91]
    v_cndmask_b32 v30, v30, v5, s[92:93]
    v_cndmask_b32 v31, v31, v5, s[94:95]
L_slow_nm2:
    v_max3_f32 v2, v16, v17, v32
    v_max3_f32 v2, v2, v18, v19
    v_max3_f32 v2, v2, v20, v21
    v_max3_f32 v2, v2, v22, v23
    v_max3_f32 v2, v2, v24, v25
    v_max3_f32 v2, v2, v26, v27
    v_max3_f32 v2, v2, v28, v29
    v_max3_f32 v2, v2, v30, v31
    v_mov_b32 v3, v2
    s_nop 1
    v_permlane32_swap_b32 v2, v3
    s_nop 1
    v_max_f32 v2, v2, v3
    v_sub_f32 v33, v32, v2
    v_exp_f32 v33, v33
    v_mov_b32 v32, v2
    v_sub_f32 v16, v16, v32
    v_sub_f32 v17, v17, v32
    v_sub_f32 v18, v18, v32
    v_sub_f32 v19, v19, v32
    v_sub_f32 v20, v20, v32
    v_sub_f32 v21, v21, v32
    v_sub_f32 v22, v22, v32
    v_sub_f32 v23, v23, v32
    v_sub_f32 v24, v24, v32
    v_sub_f32 v25, v25, v32
    v_sub_f32 v26, v26, v32
    v_sub_f32 v27, v27, v32
    v_sub_f32 v28, v28, v32
    v_sub_f32 v29, v29, v32
    v_sub_f32 v30, v30, v32
    v_sub_f32 v31, v31, v32
    v_exp_f32 v16, v16
    v_exp_f32 v17, v17
    v_exp_f32 v18, v18
    v_exp_f32 v19, v19
    v_exp_f32 v20, v20
    v_exp_f32 v21, v21
    v_exp_f32 v22, v22
    v_exp_f32 v23, v23
    v_exp_f32 v24, v24
    v_exp_f32 v25, v25
    v_exp_f32 v26, v26
    v_exp_f32 v27, v27
    v_exp_f32 v28, v28
    v_exp_f32 v29, v29
    v_exp_f32 v30, v30
    v_exp_f32 v31, v31
    v_mul_f32 v80, v33, v80
    v_mul_f32 v81, v33, v81
    v_mul_f32 v82, v33, v82
    v_mul_f32 v83, v33, v83
    v_mul_f32 v84, v33, v84
    v_mul_f32 v85, v33, v85
    v_mul_f32 v86, v33, v86
    v_mul_f32 v87, v33, v87
    v_mul_f32 v88, v33, v88
    v_mul_f32 v89, v33, v89
    v_mul_f32 v90, v33, v90
    v_mul_f32 v91, v33, v91
    v_mul_f32 v92, v33, v92
    v_mul_f32 v93, v33, v93
    v_mul_f32 v94, v33, v94
    v_mul_f32 v95, v33, v95
    v_mul_f32 v228, v33, v228
    s_nop 3
    v_smfmac_f32_32x32x32_bf16 v[80:95], v[200:203], v[16:23], v4
    v_smfmac_f32_32x32x32_bf16 v[80:95], v[204:207], v[24:31], v4
    v_smfmac_f32_16x16x64_bf16 v[228:231], v[8:11], v[16:23], v4
    v_smfmac_f32_16x16x64_bf16 v[228:231], v[8:11], v[24:31], v4
    s_nop 15
    s_add_u32 s54, s54, 4096
    s_cmp_lt_u32 s50, s55
    s_cbranch_scc1 L_slow_loop
    s_setpc_b64 s[52:53]
L_code_end:
.section .rodata,"a"

.p2align 6
.amdhsa_kernel fused_kernel
  .amdhsa_next_free_vgpr 256
  .amdhsa_next_free_sgpr 102
  .amdhsa_accum_offset 256
  .amdhsa_group_segment_fixed_size 0
  .amdhsa_kernarg_size 72
  .amdhsa_user_sgpr_count 2
  .amdhsa_user_sgpr_kernarg_segment_ptr 1
  .amdhsa_system_sgpr_workgroup_id_x 1
.end_amdhsa_kernel
```
